```python
import torch

def _softmax(x, axis=-1):
    return torch.softmax(x, dim=axis)
def _gelu(x):
    return torch.nn.functional.gelu(x, approximate="tanh")
def _silu(x):
    return torch.nn.functional.silu(x)
def _sigmoid(x):
    return torch.sigmoid(x)
def _layernorm(x, axis=-1, eps=1e-5):
    m = x.mean(dim=axis, keepdim=True)
    v = x.var(dim=axis, keepdim=True, unbiased=False)
    return (x - m) / torch.sqrt(v + eps)
def _scatter_add(tgt, idx, src, axis=0):
    return tgt.clone().index_add_(axis, idx, src)
def _segment_sum(src, seg, n):
    out = torch.zeros((n,) + src.shape[1:], dtype=src.dtype)
    return out.index_add_(0, seg, src)
def _pad(x, pw):
    flat = tuple(v for pair in reversed(pw) for v in pair)
    return torch.nn.functional.pad(x, flat)

kernel_name = 'concat_heads__linear_kernel_hedgehog__linear_attn_block__prompt'

def setup_inputs():

    _w = (lambda a: (lambda t: t.to(torch.bfloat16) if t.is_floating_point() else t)(torch.as_tensor(a)))
    def _A_setup():
        B, S, D, H = 1, 2048, 512, 32
        Dh = D // H
        return {
            "x": _w((lambda *s: torch.randn(*s, dtype=torch.bfloat16) * 0.4)(B, S, D)),
            "wqkv": _w((lambda *s: torch.randn(*s, dtype=torch.bfloat16) * 0.4)(D, 3 * D)),
            "w_phi": _w((lambda *s: torch.randn(*s, dtype=torch.bfloat16) * 0.4)(H, Dh, Dh) * (Dh ** -0.5)),
            "wo": _w((lambda *s: torch.randn(*s, dtype=torch.bfloat16) * 0.05)(D, D)),
        }
    _A_in = _A_setup()

    def _B_setup():
        B, S, D = 1, 2048, 512
        return {
            "x": _w((lambda *s: torch.randn(*s, dtype=torch.bfloat16) * 0.05)(B, S, D)),
            "wqkv": _w((lambda *s: torch.randn(*s, dtype=torch.bfloat16) * 0.8)(D, 3 * D)),
            "wo": _w((lambda *s: torch.randn(*s, dtype=torch.bfloat16) * 0.4)(D, D)),
        }
    _B_in = _B_setup()

    return {
        "A_x": _A_in["x"],
        "A_wqkv": _A_in["wqkv"],
        "A_w_phi": _A_in["w_phi"],
        "A_wo": _A_in["wo"],
        "B_x": _B_in["x"],
        "B_wqkv": _B_in["wqkv"],
        "B_wo": _B_in["wo"],
    }

def reference(A_x, A_wqkv, A_w_phi, A_wo, B_x, B_wqkv, B_wo):
    def _A_ref(x, wqkv, w_phi, wo):
        B, S, D = x.shape
        H = 32; Dh = D // H
        qkv = (lambda x, *d: x.permute(*d))((x @ wqkv).reshape(B, S, 3, H, Dh), 2, 0, 3, 1, 4)
        q, k, v = qkv[0], qkv[1], qkv[2]
        pq = torch.einsum("bhsd,hdf->bhsf", q, w_phi)
        pk = torch.einsum("bhsd,hdf->bhsf", k, w_phi)
        phi_q = torch.concatenate([_softmax(pq, axis=-1), _softmax(-pq, axis=-1)], axis=-1)
        phi_k = torch.concatenate([_softmax(pk, axis=-1), _softmax(-pk, axis=-1)], axis=-1)
        kv = torch.einsum("bhsf,bhsd->bhfd", phi_k, v)
        z  = torch.einsum("bhsf->bhf", phi_k)
        num = torch.einsum("bhqf,bhfd->bhqd", phi_q, kv)
        den = torch.einsum("bhqf,bhf->bhq", phi_q, z)[..., None] + 1e-6
        o = num / den
        return (lambda x, *d: x.permute(*d))(o, 0, 2, 1, 3).reshape(B, S, D) @ wo

    def _B_ref(x, wqkv, wo):
        B, S, D = x.shape
        H = 32; Dh = D // H
        qkv = (lambda x, *d: x.permute(*d))((x @ wqkv).reshape(B, S, 3, H, Dh), 2, 0, 3, 1, 4)
        q, k, v = qkv[0], qkv[1], qkv[2]
        phi = lambda t: torch.where(t > 0, t + 1, torch.exp(t)) + 1e-6
        pq, pk = phi(q), phi(k)
        kv = torch.einsum("bhsd,bhse->bhde", pk, v)
        z = torch.einsum("bhsd->bhd", pk)
        num = torch.einsum("bhqd,bhde->bhqe", pq, kv)
        den = torch.einsum("bhqd,bhd->bhq", pq, z)[..., None] + 1e-6
        o = num / den
        return (lambda x, *d: x.permute(*d))(o, 0, 2, 1, 3).reshape(B, S, D) @ wo

    a = _A_ref(A_x, A_wqkv, A_w_phi, A_wo)
    b = _B_ref(B_x, B_wqkv, B_wo)
    return torch.concatenate([a, b], axis=-1)
```

```asm
; @launch grid=(256,1,1) block=(512,1,1) lds=163840
.amdgcn_target "amdgcn-amd-amdhsa--gfx950"
.text
.globl concat_heads__linear_kernel_hedgehog__linear_attn_block__prompt_kernel
.p2align 8
.type concat_heads__linear_kernel_hedgehog__linear_attn_block__prompt_kernel,@function
concat_heads__linear_kernel_hedgehog__linear_attn_block__prompt_kernel:
    s_cmp_ge_u32 s2, 0x100
    s_cbranch_scc1 L_END
    s_load_dwordx16 s[4:19], s[0:1], 0
    s_load_dwordx2 s[20:21], s[0:1], 72
    v_and_b32 v1, 63, v0
    v_lshrrev_b32 v96, 6, v0
    s_and_b32 s64, s2, 7
    v_readfirstlane_b32 s56, v96
    s_lshr_b32 s65, s2, 3
    s_lshr_b32 s52, s64, 2
    s_and_b32 s66, s64, 3
    s_lshl_b32 s66, s66, 2
    s_lshr_b32 s68, s65, 3
    s_add_u32 s53, s66, s68
    s_and_b32 s54, s65, 7
    s_and_b32 s61, s65, 7
    s_lshl_b32 s70, s68, 1
    s_add_u32 s55, s54, s70
    s_and_b32 s55, s55, 7
    s_lshl_b32 s55, s55, 0
    v_lshrrev_b32 v97, 3, v1
    v_and_b32 v98, 7, v1
    v_lshrrev_b32 v99, 4, v1
    s_lshl_b32 s64, s53, 7
    s_lshl_b32 s65, s56, 4
    s_add_u32 s64, s64, s65
    v_add_u32 v100, s64, v97
    v_lshlrev_b32 v100, 10, v100
    v_xor_b32 v101, v98, v99
    v_lshl_add_u32 v2, v101, 4, v100
    v_xor_b32 v3, 64, v2
    v_add_u32 v3, 7168, v3
    v_and_b32 v101, 1, v99
    v_lshlrev_b32 v101, 2, v101
    v_xor_b32 v101, v98, v101
    v_lshlrev_b32 v101, 4, v101
    s_lshl_b32 s64, s56, 3
    v_add_u32 v102, s64, v97
    s_lshl_b32 s65, s54, 7
    v_add_u32 v101, s65, v101
    v_mul_u32_u24 v103, 3072, v102
    v_add_u32 v5, v103, v101
    v_add_u32 v4, 1024, v5
    s_mov_b32 s26, 0x200000
    s_mov_b32 s27, 0x20000
    s_mov_b32 s30, 0x180000
    s_mov_b32 s31, 0x20000
    s_add_u32 s72, s55, 0
    s_and_b32 s72, s72, 7
    s_lshl_b32 s73, s56, 12
    s_mul_i32 s74, s72, 196608
    s_lshl_b32 s75, s72, 7
    s_cmp_eq_u32 s52, 0
    s_waitcnt lgkmcnt(0)
    s_cselect_b32 s24, s4, s12
    s_cselect_b32 s25, s5, s13
    s_cselect_b32 s28, s6, s14
    s_cselect_b32 s29, s7, s15
    s_cselect_b32 s32, s10, s16
    s_cselect_b32 s33, s11, s17
    s_add_u32 m0, s73, 0
    s_nop 0
    buffer_load_dwordx4 v4, s[28:31], s74 offen lds
    buffer_load_dwordx4 v4, s[28:31], s74 offen offset:1024 lds
    s_add_u32 m0, s73, 2048
    s_nop 0
    buffer_load_dwordx4 v2, s[24:27], s75 offen lds
    buffer_load_dwordx4 v3, s[24:27], s75 offen offset:1024 lds
    s_add_u32 s72, s55, 1
    s_and_b32 s72, s72, 7
    s_lshl_b32 s73, s56, 12
    s_mul_i32 s74, s72, 196608
    s_lshl_b32 s75, s72, 7
    s_add_u32 m0, s73, 32768
    s_nop 0
    buffer_load_dwordx4 v4, s[28:31], s74 offen lds
    buffer_load_dwordx4 v4, s[28:31], s74 offen offset:1024 lds
    s_add_u32 m0, s73, 34816
    s_nop 0
    buffer_load_dwordx4 v2, s[24:27], s75 offen lds
    buffer_load_dwordx4 v3, s[24:27], s75 offen offset:1024 lds
    s_add_u32 s72, s55, 2
    s_and_b32 s72, s72, 7
    s_lshl_b32 s73, s56, 12
    s_mul_i32 s74, s72, 196608
    s_lshl_b32 s75, s72, 7
    s_add_u32 m0, s73, 65536
    s_nop 0
    buffer_load_dwordx4 v4, s[28:31], s74 offen lds
    buffer_load_dwordx4 v4, s[28:31], s74 offen offset:1024 lds
    s_add_u32 m0, s73, 67584
    s_nop 0
    buffer_load_dwordx4 v2, s[24:27], s75 offen lds
    buffer_load_dwordx4 v3, s[24:27], s75 offen offset:1024 lds
    v_lshl_add_u32 v6, v102, 10, v101
    v_lshlrev_b32 v26, 4, v1
    s_add_u32 s20, s20, 260046848
    s_addc_u32 s21, s21, 0
    s_mov_b32 s44, s8
    s_mov_b32 s45, s9
    s_mov_b32 s46, 0x4000
    s_mov_b32 s47, 0x20000
    s_lshr_b32 s66, s56, 1
    s_or_b32 s66, s66, s52
    s_cmp_lg_u32 s66, 0
    s_cbranch_scc1 L_nophi_1
    s_lshl_b32 s64, s56, 10
    s_add_u32 m0, s64, 131072
    s_lshl_b32 s65, s54, 11
    s_add_u32 s65, s65, s64
    buffer_load_dwordx4 v26, s[44:47], s65 offen lds
L_nophi_1:
    s_and_b32 s57, s56, 3
    s_lshr_b32 s58, s56, 2
    s_mov_b32 s62, 0x3fb8aa3b
    s_mov_b32 s63, 0x3fb8aa3b
    s_mov_b32 s98, 0x358637bd
    s_mov_b32 s99, 0x358637bd
    s_mov_b32 s34, 0x80000
    s_mov_b32 s35, 0x20000
    s_mov_b32 s36, s20
    s_mov_b32 s37, s21
    s_mov_b32 s38, 8388608
    s_mov_b32 s39, 0x20000
    s_mov_b32 s40, s18
    s_mov_b32 s41, s19
    s_mov_b32 s42, 0x400000
    s_mov_b32 s43, 0x20000
    s_lshl_b32 s64, s52, 4
    s_add_u32 s64, s64, s53
    s_lshl_b32 s64, s64, 17
    s_add_u32 s64, s64, 3145728
    s_add_u32 s48, s20, s64
    s_addc_u32 s49, s21, 0
    s_mov_b32 s50, 0x20000
    s_mov_b32 s51, 0x20000
    s_lshl_b32 s64, s52, 8
    s_load_dword s60, s[20:21], s64
    v_lshrrev_b32 v96, 5, v1
    v_bfe_u32 v97, v1, 2, 2
    v_and_b32 v98, 3, v1
    v_bfe_u32 v99, v1, 4, 1
    v_and_b32 v100, 31, v1
    v_and_b32 v101, 15, v1
    v_lshrrev_b32 v102, 1, v97
    v_xor_b32 v103, s58, v102
    v_lshlrev_b32 v103, 2, v103
    v_lshl_add_u32 v103, v99, 1, v103
    v_lshrrev_b32 v104, 1, v98
    v_add_u32 v103, v103, v104
    v_lshlrev_b32 v103, 4, v103
    v_and_b32 v105, 1, v98
    v_lshl_add_u32 v103, v105, 3, v103
    v_lshl_add_u32 v103, v97, 7, v103
    v_lshl_add_u32 v7, v96, 12, v103
    v_lshrrev_b32 v103, 4, v100
    s_lshl_b32 s64, s57, 1
    v_add_u32 v103, s64, v103
    v_lshlrev_b32 v103, 12, v103
    v_bfe_u32 v106, v100, 3, 1
    v_lshl_add_u32 v103, v106, 10, v103
    v_and_b32 v106, 7, v100
    v_lshl_add_u32 v103, v106, 7, v103
    v_add_u32 v103, 2048, v103
    v_bfe_u32 v106, v100, 1, 3
    v_xor_b32 v107, v96, v106
    v_lshl_add_u32 v8, v107, 4, v103
    v_xor_b32 v9, 32, v8
    v_xor_b32 v10, 64, v8
    v_xor_b32 v11, 96, v8
    s_cmp_lg_u32 s56, 6
    s_cbranch_scc1 L_notlb_2
    v_and_b32 v243, 3, v1
    v_lshlrev_b32 v243, 21, v243
    v_add_u32 v244, 0x100000, v243
    buffer_load_dword v245, v244, s[36:39], 0 offen
    v_and_b32 v243, 1, v1
    v_lshlrev_b32 v243, 21, v243
    v_add_u32 v243, 0x100000, v243
    buffer_load_dword v246, v243, s[40:43], 0 offen
    v_mov_b32 v243, 0
    buffer_load_dword v247, v243, s[32:35], 0 offen
L_notlb_2:
    s_lshl_b32 s86, s57, 5
    v_add_u32 v108, s86, v100
    s_lshl_b32 s87, s58, 2
    v_add_u32 v109, s87, v96
    v_lshlrev_b32 v109, 11, v109
    v_lshl_add_u32 v24, v108, 4, v109
    s_lshl_b32 s87, s53, 7
    v_add_u32 v109, s87, v108
    v_lshlrev_b32 v109, 11, v109
    v_lshl_add_u32 v25, v96, 4, v109
    v_and_b32 v106, 3, v106
    v_lshlrev_b32 v108, 6, v108
    v_xor_b32 v109, v96, v106
    v_lshl_add_u32 v109, v109, 4, v108
    s_lshl_b32 s87, s58, 14
    s_add_u32 s88, s87, 131072
    v_add_u32 v12, s88, v109
    v_lshlrev_b32 v110, 1, v96
    v_xor_b32 v110, v110, v106
    v_lshl_add_u32 v110, v110, 4, v108
    s_add_u32 s88, s87, 98304
    s_lshl_b32 s89, s58, 13
    s_add_u32 s89, s89, 98304
    s_cmp_eq_u32 s52, 0
    s_cselect_b32 s88, s88, s89
    s_cselect_b64 vcc, -1, 0
    v_cndmask_b32 v110, v109, v110, vcc
    v_add_u32 v13, s88, v110
    v_lshl_add_u32 v104, v99, 1, v104
    v_xor_b32 v104, v104, v102
    v_xor_b32 v106, 2, v104
    v_lshl_add_u32 v107, v96, 3, v97
    v_lshlrev_b32 v107, 6, v107
    v_lshl_add_u32 v107, v105, 3, v107
    v_lshl_add_u32 v104, v104, 4, v107
    v_lshl_add_u32 v106, v106, 4, v107
    v_add_u32 v106, 256, v106
    s_lshr_b32 s86, s56, s52
    s_lshl_b32 s86, s86, 13
    s_add_u32 s86, s86, 98304
    s_lshl_b32 s87, s56, 13
    s_add_u32 s87, s87, 131072
    v_add_u32 v14, s86, v104
    v_add_u32 v15, s86, v106
    v_add_u32 v16, s87, v104
    v_add_u32 v17, s87, v106
    v_lshl_add_u32 v104, v96, 4, v101
    v_lshlrev_b32 v104, 4, v104
    s_lshl_b32 s86, s53, 9
    v_add_u32 v18, s86, v104
    v_and_b32 v104, 3, v1
    s_lshl_b32 s86, s56, 2
    v_add_u32 v104, s86, v104
    v_lshlrev_b32 v20, 4, v104
    v_lshrrev_b32 v104, 2, v1
    v_lshl_add_u32 v19, v104, 9, v20
    v_lshlrev_b32 v29, 4, v0
    v_lshrrev_b32 v104, 7, v0
    v_bfe_u32 v105, v0, 5, 2
    v_lshrrev_b32 v106, 1, v105
    v_and_b32 v105, 1, v105
    v_lshlrev_b32 v107, 2, v104
    v_lshl_add_u32 v107, v99, 1, v107
    v_add_u32 v107, v107, v106
    v_lshlrev_b32 v107, 9, v107
    v_lshl_add_u32 v107, v105, 3, v107
    v_lshl_add_u32 v108, v104, 1, v106
    v_lshlrev_b32 v108, 9, v108
    v_lshl_add_u32 v109, v99, 1, v105
    v_lshl_add_u32 v108, v109, 2, v108
    v_cndmask_b32 v107, v108, v107, vcc
    v_add_u32 v107, 131072, v107
    v_lshl_add_u32 v21, v101, 4, v107
    v_lshl_add_u32 v22, v101, 2, v107
    v_add_u32 v22, 256, v22
    v_min_u32 v104, 16, v100
    v_lshlrev_b32 v104, 4, v104
    v_lshl_add_u32 v104, v96, 9, v104
    s_sub_u32 s87, 12, s52
    s_lshl_b32 s86, s58, s87
    s_add_u32 s86, s86, 131072
    v_add_u32 v23, s86, v104
    s_lshr_b32 s86, s56, 2
    s_lshl_b32 s86, s86, 3
    s_bfe_u32 s87, s56, 0x10001
    s_add_u32 s86, s86, s87
    s_lshl_b32 s86, s86, 11
    s_and_b32 s87, s56, 1
    s_lshl_b32 s87, s87, 9
    s_add_u32 s86, s86, s87
    v_lshlrev_b32 v104, 12, v96
    v_lshl_add_u32 v104, v100, 4, v104
    v_add_u32 v27, s86, v104
    v_add_u32 v28, 8192, v27
    v_bfe_u32 v104, v0, 1, 2
    v_xor_b32 v104, 2, v104
    v_lshlrev_b32 v104, 4, v104
    v_lshl_add_u32 v104, v0, 6, v104
    v_add_u32 v104, 131072, v104
    v_xor_b32 v105, 16, v104
    v_mov_b32 v108, 0x3f803f80
    v_mov_b32 v109, 0x3f803f80
    v_mov_b32 v110, 0x3f803f80
    v_mov_b32 v111, 0x3f803f80
    v_lshrrev_b32 v240, 5, v1
    v_bfe_u32 v241, v1, 2, 2
    v_lshl_add_u32 v240, v240, 2, v241
    v_lshlrev_b32 v240, 5, v240
    s_lshl_b32 s64, s58, 10
    s_add_u32 s64, s64, 131072
    v_add_u32 v240, s64, v240
    v_bfe_u32 v241, v1, 4, 1
    v_bfe_u32 v242, v1, 1, 1
    v_lshl_add_u32 v243, v241, 1, v242
    v_lshl_add_u32 v244, v242, 1, v241
    v_lshl_add_u32 v96, v243, 3, v240
    v_lshl_add_u32 v97, v244, 3, v240
    v_bfe_u32 v240, v1, 2, 1
    v_mov_b32 v241, 0x80008000
    v_mul_lo_u32 v98, v240, v241
    s_lshl_b32 s95, s53, 18
    s_lshl_b32 s86, s52, 10
    s_add_u32 s95, s95, s86
    s_lshl_b32 s86, s54, 15
    s_add_u32 s86, s86, s95
    s_lshl_b32 s87, s56, 12
    s_add_u32 s91, s86, s87
    s_lshl_b32 s86, s52, 4
    s_add_u32 s86, s86, s53
    s_lshl_b32 s86, s86, 10
    s_lshl_b32 s87, s54, 7
    s_add_u32 s87, s87, s86
    s_add_u32 s92, s87, 4096
    s_add_u32 s93, s87, 196608
    s_add_u32 s85, s86, 196608
    s_waitcnt vmcnt(8) lgkmcnt(0)
    s_barrier
    ds_read_b128 v[128:131], v8 offset:0
    ds_read_b64_tr_b16 v[32:33], v7 offset:0
    ds_read_b64_tr_b16 v[34:35], v7 offset:512
    ds_read_b64_tr_b16 v[36:37], v7 offset:1024
    ds_read_b64_tr_b16 v[38:39], v7 offset:1536
    ds_read_b128 v[132:135], v9 offset:0
    ds_read_b64_tr_b16 v[40:41], v7 offset:8192
    ds_read_b64_tr_b16 v[42:43], v7 offset:8704
    ds_read_b64_tr_b16 v[44:45], v7 offset:9216
    ds_read_b64_tr_b16 v[46:47], v7 offset:9728
    s_add_u32 s72, s55, 3
    s_and_b32 s72, s72, 7
    s_lshl_b32 s73, s56, 12
    s_mul_i32 s74, s72, 196608
    s_lshl_b32 s75, s72, 7
    s_add_u32 m0, s73, 98304
    s_nop 0
    buffer_load_dwordx4 v4, s[28:31], s74 offen lds
    buffer_load_dwordx4 v4, s[28:31], s74 offen offset:1024 lds
    s_waitcnt lgkmcnt(5)
    v_mfma_f32_32x32x16_bf16 v[64:79], v[32:35], v[128:131], 0
    ds_read_b128 v[136:139], v10 offset:0
    ds_read_b64_tr_b16 v[48:49], v7 offset:16384
    ds_read_b64_tr_b16 v[50:51], v7 offset:16896
    ds_read_b64_tr_b16 v[52:53], v7 offset:17408
    v_mfma_f32_32x32x16_bf16 v[80:95], v[36:39], v[128:131], 0
    ds_read_b64_tr_b16 v[54:55], v7 offset:17920
    ds_read_b128 v[140:143], v11 offset:0
    ds_read_b64_tr_b16 v[56:57], v7 offset:24576
    s_waitcnt lgkmcnt(7)
    v_mfma_f32_32x32x16_bf16 v[64:79], v[40:43], v[132:135], v[64:79]
    ds_read_b64_tr_b16 v[58:59], v7 offset:25088
    ds_read_b64_tr_b16 v[60:61], v7 offset:25600
    ds_read_b64_tr_b16 v[62:63], v7 offset:26112
    s_add_u32 m0, s73, 100352
    s_nop 0
    buffer_load_dwordx4 v2, s[24:27], s75 offen lds
    v_mfma_f32_32x32x16_bf16 v[80:95], v[44:47], v[132:135], v[80:95]
    buffer_load_dwordx4 v3, s[24:27], s75 offen offset:1024 lds
    s_waitcnt vmcnt(8) lgkmcnt(0)
    s_barrier
    v_mfma_f32_32x32x16_bf16 v[64:79], v[48:51], v[136:139], v[64:79]
    ds_read_b128 v[144:147], v8 offset:32768
    ds_read_b64_tr_b16 v[32:33], v7 offset:32768
    ds_read_b64_tr_b16 v[34:35], v7 offset:33280
    ds_read_b64_tr_b16 v[36:37], v7 offset:33792
    v_mfma_f32_32x32x16_bf16 v[80:95], v[52:55], v[136:139], v[80:95]
    ds_read_b64_tr_b16 v[38:39], v7 offset:34304
    ds_read_b128 v[148:151], v9 offset:32768
    ds_read_b64_tr_b16 v[40:41], v7 offset:40960
    s_add_u32 s72, s55, 4
    s_and_b32 s72, s72, 7
    s_lshl_b32 s73, s56, 12
    s_mul_i32 s74, s72, 196608
    s_lshl_b32 s75, s72, 7
    v_mfma_f32_32x32x16_bf16 v[64:79], v[56:59], v[140:143], v[64:79]
    ds_read_b64_tr_b16 v[42:43], v7 offset:41472
    ds_read_b64_tr_b16 v[44:45], v7 offset:41984
    ds_read_b64_tr_b16 v[46:47], v7 offset:42496
    s_add_u32 m0, s73, 0
    s_nop 0
    buffer_load_dwordx4 v4, s[28:31], s74 offen lds
    v_mfma_f32_32x32x16_bf16 v[80:95], v[60:63], v[140:143], v[80:95]
    buffer_load_dwordx4 v4, s[28:31], s74 offen offset:1024 lds
    s_waitcnt lgkmcnt(5)
    v_mfma_f32_32x32x16_bf16 v[64:79], v[32:35], v[144:147], v[64:79]
    ds_read_b128 v[152:155], v10 offset:32768
    ds_read_b64_tr_b16 v[48:49], v7 offset:49152
    ds_read_b64_tr_b16 v[50:51], v7 offset:49664
    ds_read_b64_tr_b16 v[52:53], v7 offset:50176
    v_mfma_f32_32x32x16_bf16 v[80:95], v[36:39], v[144:147], v[80:95]
    ds_read_b64_tr_b16 v[54:55], v7 offset:50688
    ds_read_b128 v[156:159], v11 offset:32768
    ds_read_b64_tr_b16 v[56:57], v7 offset:57344
    s_waitcnt lgkmcnt(7)
    v_mfma_f32_32x32x16_bf16 v[64:79], v[40:43], v[148:151], v[64:79]
    ds_read_b64_tr_b16 v[58:59], v7 offset:57856
    ds_read_b64_tr_b16 v[60:61], v7 offset:58368
    ds_read_b64_tr_b16 v[62:63], v7 offset:58880
    s_add_u32 m0, s73, 2048
    s_nop 0
    buffer_load_dwordx4 v2, s[24:27], s75 offen lds
    v_mfma_f32_32x32x16_bf16 v[80:95], v[44:47], v[148:151], v[80:95]
    buffer_load_dwordx4 v3, s[24:27], s75 offen offset:1024 lds
    v_xor_b32 v7, 0x10000, v7
    v_xor_b32 v8, 0x10000, v8
    v_xor_b32 v9, 0x10000, v9
    v_xor_b32 v10, 0x10000, v10
    v_xor_b32 v11, 0x10000, v11
    s_add_u32 s59, s60, 1
    s_mul_i32 s59, s59, 0x9E3779B1
    s_getreg_b32 s64, hwreg(HW_REG_XCC_ID, 0, 4)
    s_add_u32 s23, s59, s64
    s_cmp_lg_u32 s56, 0
    s_cbranch_scc1 L_noxid_3
    v_mov_b32 v30, s23
    s_mov_b64 exec, 1
    buffer_store_dword v30, v26, s[36:39], s93 offen sc1
    s_mov_b64 exec, -1
L_noxid_3:
    s_waitcnt vmcnt(8) lgkmcnt(0)
    s_barrier
    v_mfma_f32_32x32x16_bf16 v[64:79], v[48:51], v[152:155], v[64:79]
    ds_read_b128 v[160:163], v8 offset:0
    ds_read_b64_tr_b16 v[32:33], v7 offset:0
    ds_read_b64_tr_b16 v[34:35], v7 offset:512
    ds_read_b64_tr_b16 v[36:37], v7 offset:1024
    v_mfma_f32_32x32x16_bf16 v[80:95], v[52:55], v[152:155], v[80:95]
    ds_read_b64_tr_b16 v[38:39], v7 offset:1536
    ds_read_b128 v[164:167], v9 offset:0
    ds_read_b64_tr_b16 v[40:41], v7 offset:8192
    s_add_u32 s72, s55, 5
    s_and_b32 s72, s72, 7
    s_lshl_b32 s73, s56, 12
    s_mul_i32 s74, s72, 196608
    s_lshl_b32 s75, s72, 7
    v_mfma_f32_32x32x16_bf16 v[64:79], v[56:59], v[156:159], v[64:79]
    ds_read_b64_tr_b16 v[42:43], v7 offset:8704
    ds_read_b64_tr_b16 v[44:45], v7 offset:9216
    ds_read_b64_tr_b16 v[46:47], v7 offset:9728
    s_add_u32 m0, s73, 32768
    s_nop 0
    buffer_load_dwordx4 v4, s[28:31], s74 offen lds
    v_mfma_f32_32x32x16_bf16 v[80:95], v[60:63], v[156:159], v[80:95]
    buffer_load_dwordx4 v4, s[28:31], s74 offen offset:1024 lds
    s_waitcnt lgkmcnt(5)
    v_mfma_f32_32x32x16_bf16 v[64:79], v[32:35], v[160:163], v[64:79]
    ds_read_b128 v[168:171], v10 offset:0
    ds_read_b64_tr_b16 v[48:49], v7 offset:16384
    ds_read_b64_tr_b16 v[50:51], v7 offset:16896
    ds_read_b64_tr_b16 v[52:53], v7 offset:17408
    v_mfma_f32_32x32x16_bf16 v[80:95], v[36:39], v[160:163], v[80:95]
    ds_read_b64_tr_b16 v[54:55], v7 offset:17920
    ds_read_b128 v[172:175], v11 offset:0
    ds_read_b64_tr_b16 v[56:57], v7 offset:24576
    s_waitcnt lgkmcnt(7)
    v_mfma_f32_32x32x16_bf16 v[64:79], v[40:43], v[164:167], v[64:79]
    ds_read_b64_tr_b16 v[58:59], v7 offset:25088
    ds_read_b64_tr_b16 v[60:61], v7 offset:25600
    ds_read_b64_tr_b16 v[62:63], v7 offset:26112
    s_add_u32 m0, s73, 34816
    s_nop 0
    buffer_load_dwordx4 v2, s[24:27], s75 offen lds
    v_mfma_f32_32x32x16_bf16 v[80:95], v[44:47], v[164:167], v[80:95]
    buffer_load_dwordx4 v3, s[24:27], s75 offen offset:1024 lds
    s_cmp_lg_u32 s52, 0
    s_cbranch_scc1 L_nowphi_4
    s_waitcnt lgkmcnt(7)
    ds_read_b64_tr_b16 v[112:113], v96
    ds_read_b64_tr_b16 v[114:115], v96 offset:256
    ds_read_b64_tr_b16 v[116:117], v96 offset:512
    ds_read_b64_tr_b16 v[118:119], v96 offset:768
    ds_read_b64_tr_b16 v[120:121], v97
    ds_read_b64_tr_b16 v[122:123], v97 offset:256
    ds_read_b64_tr_b16 v[124:125], v97 offset:512
    ds_read_b64_tr_b16 v[126:127], v97 offset:768
L_nowphi_4:
    s_waitcnt vmcnt(8) lgkmcnt(0)
    s_barrier
    v_mfma_f32_32x32x16_bf16 v[64:79], v[48:51], v[168:171], v[64:79]
    ds_read_b128 v[176:179], v8 offset:32768
    ds_read_b64_tr_b16 v[32:33], v7 offset:32768
    ds_read_b64_tr_b16 v[34:35], v7 offset:33280
    ds_read_b64_tr_b16 v[36:37], v7 offset:33792
    v_mfma_f32_32x32x16_bf16 v[80:95], v[52:55], v[168:171], v[80:95]
    ds_read_b64_tr_b16 v[38:39], v7 offset:34304
    ds_read_b128 v[180:183], v9 offset:32768
    ds_read_b64_tr_b16 v[40:41], v7 offset:40960
    s_add_u32 s72, s55, 6
    s_and_b32 s72, s72, 7
    s_lshl_b32 s73, s56, 12
    s_mul_i32 s74, s72, 196608
    s_lshl_b32 s75, s72, 7
    v_mfma_f32_32x32x16_bf16 v[64:79], v[56:59], v[172:175], v[64:79]
    ds_read_b64_tr_b16 v[42:43], v7 offset:41472
    ds_read_b64_tr_b16 v[44:45], v7 offset:41984
    ds_read_b64_tr_b16 v[46:47], v7 offset:42496
    s_add_u32 m0, s73, 65536
    s_nop 0
    buffer_load_dwordx4 v4, s[28:31], s74 offen lds
    v_mfma_f32_32x32x16_bf16 v[80:95], v[60:63], v[172:175], v[80:95]
    buffer_load_dwordx4 v4, s[28:31], s74 offen offset:1024 lds
    s_waitcnt lgkmcnt(5)
    v_mfma_f32_32x32x16_bf16 v[64:79], v[32:35], v[176:179], v[64:79]
    ds_read_b128 v[184:187], v10 offset:32768
    ds_read_b64_tr_b16 v[48:49], v7 offset:49152
    ds_read_b64_tr_b16 v[50:51], v7 offset:49664
    ds_read_b64_tr_b16 v[52:53], v7 offset:50176
    v_mfma_f32_32x32x16_bf16 v[80:95], v[36:39], v[176:179], v[80:95]
    ds_read_b64_tr_b16 v[54:55], v7 offset:50688
    ds_read_b128 v[188:191], v11 offset:32768
    ds_read_b64_tr_b16 v[56:57], v7 offset:57344
    s_waitcnt lgkmcnt(7)
    v_mfma_f32_32x32x16_bf16 v[64:79], v[40:43], v[180:183], v[64:79]
    ds_read_b64_tr_b16 v[58:59], v7 offset:57856
    ds_read_b64_tr_b16 v[60:61], v7 offset:58368
    ds_read_b64_tr_b16 v[62:63], v7 offset:58880
    s_add_u32 m0, s73, 67584
    s_nop 0
    buffer_load_dwordx4 v2, s[24:27], s75 offen lds
    v_mfma_f32_32x32x16_bf16 v[80:95], v[44:47], v[180:183], v[80:95]
    buffer_load_dwordx4 v3, s[24:27], s75 offen offset:1024 lds
    v_xor_b32 v7, 0x10000, v7
    v_xor_b32 v8, 0x10000, v8
    v_xor_b32 v9, 0x10000, v9
    v_xor_b32 v10, 0x10000, v10
    v_xor_b32 v11, 0x10000, v11
    s_cmp_lg_u32 s52, 0
    s_cbranch_scc1 L_nowx_5
    v_xor_b32 v112, v98, v112
    v_xor_b32 v113, v98, v113
    v_xor_b32 v114, v98, v114
    v_xor_b32 v115, v98, v115
    v_xor_b32 v116, v98, v116
    v_xor_b32 v117, v98, v117
    v_xor_b32 v118, v98, v118
    v_xor_b32 v119, v98, v119
    v_xor_b32 v120, v98, v120
    v_xor_b32 v121, v98, v121
    v_xor_b32 v122, v98, v122
    v_xor_b32 v123, v98, v123
    v_xor_b32 v124, v98, v124
    v_xor_b32 v125, v98, v125
    v_xor_b32 v126, v98, v126
    v_xor_b32 v127, v98, v127
L_nowx_5:
    s_waitcnt vmcnt(8) lgkmcnt(0)
    s_barrier
    v_mfma_f32_32x32x16_bf16 v[64:79], v[48:51], v[184:187], v[64:79]
    ds_read_b128 v[192:195], v8 offset:0
    ds_read_b64_tr_b16 v[32:33], v7 offset:0
    ds_read_b64_tr_b16 v[34:35], v7 offset:512
    ds_read_b64_tr_b16 v[36:37], v7 offset:1024
    v_mfma_f32_32x32x16_bf16 v[80:95], v[52:55], v[184:187], v[80:95]
    ds_read_b64_tr_b16 v[38:39], v7 offset:1536
    ds_read_b128 v[196:199], v9 offset:0
    ds_read_b64_tr_b16 v[40:41], v7 offset:8192
    s_add_u32 s72, s55, 7
    s_and_b32 s72, s72, 7
    s_lshl_b32 s73, s56, 12
    s_mul_i32 s74, s72, 196608
    s_lshl_b32 s75, s72, 7
    v_mfma_f32_32x32x16_bf16 v[64:79], v[56:59], v[188:191], v[64:79]
    ds_read_b64_tr_b16 v[42:43], v7 offset:8704
    ds_read_b64_tr_b16 v[44:45], v7 offset:9216
    ds_read_b64_tr_b16 v[46:47], v7 offset:9728
    s_add_u32 m0, s73, 98304
    s_nop 0
    buffer_load_dwordx4 v4, s[28:31], s74 offen lds
    v_mfma_f32_32x32x16_bf16 v[80:95], v[60:63], v[188:191], v[80:95]
    buffer_load_dwordx4 v4, s[28:31], s74 offen offset:1024 lds
    s_waitcnt lgkmcnt(5)
    v_mfma_f32_32x32x16_bf16 v[64:79], v[32:35], v[192:195], v[64:79]
    ds_read_b128 v[200:203], v10 offset:0
    ds_read_b64_tr_b16 v[48:49], v7 offset:16384
    ds_read_b64_tr_b16 v[50:51], v7 offset:16896
    ds_read_b64_tr_b16 v[52:53], v7 offset:17408
    v_mfma_f32_32x32x16_bf16 v[80:95], v[36:39], v[192:195], v[80:95]
    ds_read_b64_tr_b16 v[54:55], v7 offset:17920
    ds_read_b128 v[204:207], v11 offset:0
    ds_read_b64_tr_b16 v[56:57], v7 offset:24576
    s_waitcnt lgkmcnt(7)
    v_mfma_f32_32x32x16_bf16 v[64:79], v[40:43], v[196:199], v[64:79]
    ds_read_b64_tr_b16 v[58:59], v7 offset:25088
    ds_read_b64_tr_b16 v[60:61], v7 offset:25600
    ds_read_b64_tr_b16 v[62:63], v7 offset:26112
    s_add_u32 m0, s73, 100352
    s_nop 0
    buffer_load_dwordx4 v2, s[24:27], s75 offen lds
    v_mfma_f32_32x32x16_bf16 v[80:95], v[44:47], v[196:199], v[80:95]
    buffer_load_dwordx4 v3, s[24:27], s75 offen offset:1024 lds
    s_waitcnt vmcnt(8) lgkmcnt(0)
    s_barrier
    v_mfma_f32_32x32x16_bf16 v[64:79], v[48:51], v[200:203], v[64:79]
    ds_read_b128 v[208:211], v8 offset:32768
    ds_read_b64_tr_b16 v[32:33], v7 offset:32768
    ds_read_b64_tr_b16 v[34:35], v7 offset:33280
    ds_read_b64_tr_b16 v[36:37], v7 offset:33792
    v_mfma_f32_32x32x16_bf16 v[80:95], v[52:55], v[200:203], v[80:95]
    ds_read_b64_tr_b16 v[38:39], v7 offset:34304
    ds_read_b128 v[212:215], v9 offset:32768
    ds_read_b64_tr_b16 v[40:41], v7 offset:40960
    s_lshl_b32 s73, s56, 12
    v_mfma_f32_32x32x16_bf16 v[64:79], v[56:59], v[204:207], v[64:79]
    ds_read_b64_tr_b16 v[42:43], v7 offset:41472
    ds_read_b64_tr_b16 v[44:45], v7 offset:41984
    ds_read_b64_tr_b16 v[46:47], v7 offset:42496
    s_add_u32 s72, s55, 0
    s_and_b32 s72, s72, 7
    s_add_u32 m0, s73, 0
    s_mul_i32 s74, s72, 196608
    buffer_load_dwordx4 v5, s[28:31], s74 offen lds
    v_mfma_f32_32x32x16_bf16 v[80:95], v[60:63], v[204:207], v[80:95]
    s_add_u32 s72, s55, 1
    s_and_b32 s72, s72, 7
    s_add_u32 m0, s73, 1024
    s_mul_i32 s74, s72, 196608
    buffer_load_dwordx4 v5, s[28:31], s74 offen lds
    s_waitcnt lgkmcnt(5)
    v_mfma_f32_32x32x16_bf16 v[64:79], v[32:35], v[208:211], v[64:79]
    ds_read_b128 v[216:219], v10 offset:32768
    ds_read_b64_tr_b16 v[48:49], v7 offset:49152
    ds_read_b64_tr_b16 v[50:51], v7 offset:49664
    ds_read_b64_tr_b16 v[52:53], v7 offset:50176
    v_mfma_f32_32x32x16_bf16 v[80:95], v[36:39], v[208:211], v[80:95]
    ds_read_b64_tr_b16 v[54:55], v7 offset:50688
    ds_read_b128 v[220:223], v11 offset:32768
    ds_read_b64_tr_b16 v[56:57], v7 offset:57344
    s_waitcnt lgkmcnt(7)
    v_mfma_f32_32x32x16_bf16 v[64:79], v[40:43], v[212:215], v[64:79]
    ds_read_b64_tr_b16 v[58:59], v7 offset:57856
    ds_read_b64_tr_b16 v[60:61], v7 offset:58368
    ds_read_b64_tr_b16 v[62:63], v7 offset:58880
    s_add_u32 s72, s55, 2
    s_and_b32 s72, s72, 7
    s_add_u32 m0, s73, 2048
    s_mul_i32 s74, s72, 196608
    buffer_load_dwordx4 v5, s[28:31], s74 offen lds
    v_mfma_f32_32x32x16_bf16 v[80:95], v[44:47], v[212:215], v[80:95]
    s_add_u32 s72, s55, 3
    s_and_b32 s72, s72, 7
    s_add_u32 m0, s73, 3072
    s_mul_i32 s74, s72, 196608
    buffer_load_dwordx4 v5, s[28:31], s74 offen lds
    v_xor_b32 v7, 0x10000, v7
    v_xor_b32 v8, 0x10000, v8
    v_xor_b32 v9, 0x10000, v9
    v_xor_b32 v10, 0x10000, v10
    v_xor_b32 v11, 0x10000, v11
    ds_write_b128 v104, v[108:111]
    ds_write_b128 v105, v[108:111]
    s_waitcnt vmcnt(8) lgkmcnt(0)
    s_barrier
    v_mfma_f32_32x32x16_bf16 v[64:79], v[48:51], v[216:219], v[64:79]
    ds_read_b128 v[224:227], v8 offset:0
    ds_read_b64_tr_b16 v[32:33], v7 offset:0
    ds_read_b64_tr_b16 v[34:35], v7 offset:512
    ds_read_b64_tr_b16 v[36:37], v7 offset:1024
    v_mfma_f32_32x32x16_bf16 v[80:95], v[52:55], v[216:219], v[80:95]
    ds_read_b64_tr_b16 v[38:39], v7 offset:1536
    ds_read_b128 v[228:231], v9 offset:0
    ds_read_b64_tr_b16 v[40:41], v7 offset:8192
    s_lshl_b32 s73, s56, 12
    v_mfma_f32_32x32x16_bf16 v[64:79], v[56:59], v[220:223], v[64:79]
    ds_read_b64_tr_b16 v[42:43], v7 offset:8704
    ds_read_b64_tr_b16 v[44:45], v7 offset:9216
    ds_read_b64_tr_b16 v[46:47], v7 offset:9728
    s_add_u32 s72, s55, 4
    s_and_b32 s72, s72, 7
    s_add_u32 m0, s73, 32768
    s_mul_i32 s74, s72, 196608
    buffer_load_dwordx4 v5, s[28:31], s74 offen lds
    v_mfma_f32_32x32x16_bf16 v[80:95], v[60:63], v[220:223], v[80:95]
    s_add_u32 s72, s55, 5
    s_and_b32 s72, s72, 7
    s_add_u32 m0, s73, 33792
    s_mul_i32 s74, s72, 196608
    buffer_load_dwordx4 v5, s[28:31], s74 offen lds
    s_waitcnt lgkmcnt(5)
    v_mfma_f32_32x32x16_bf16 v[64:79], v[32:35], v[224:227], v[64:79]
    ds_read_b128 v[232:235], v10 offset:0
    ds_read_b64_tr_b16 v[48:49], v7 offset:16384
    ds_read_b64_tr_b16 v[50:51], v7 offset:16896
    ds_read_b64_tr_b16 v[52:53], v7 offset:17408
    v_mfma_f32_32x32x16_bf16 v[80:95], v[36:39], v[224:227], v[80:95]
    ds_read_b64_tr_b16 v[54:55], v7 offset:17920
    ds_read_b128 v[236:239], v11 offset:0
    ds_read_b64_tr_b16 v[56:57], v7 offset:24576
    s_waitcnt lgkmcnt(7)
    v_mfma_f32_32x32x16_bf16 v[64:79], v[40:43], v[228:231], v[64:79]
    ds_read_b64_tr_b16 v[58:59], v7 offset:25088
    ds_read_b64_tr_b16 v[60:61], v7 offset:25600
    ds_read_b64_tr_b16 v[62:63], v7 offset:26112
    s_add_u32 s72, s55, 6
    s_and_b32 s72, s72, 7
    s_add_u32 m0, s73, 34816
    s_mul_i32 s74, s72, 196608
    buffer_load_dwordx4 v5, s[28:31], s74 offen lds
    v_mfma_f32_32x32x16_bf16 v[80:95], v[44:47], v[228:231], v[80:95]
    s_add_u32 s72, s55, 7
    s_and_b32 s72, s72, 7
    s_add_u32 m0, s73, 35840
    s_mul_i32 s74, s72, 196608
    buffer_load_dwordx4 v5, s[28:31], s74 offen lds
    s_waitcnt vmcnt(8) lgkmcnt(0)
    s_barrier
    v_mfma_f32_32x32x16_bf16 v[64:79], v[48:51], v[232:235], v[64:79]
    ds_read_b128 v[240:243], v8 offset:32768
    ds_read_b64_tr_b16 v[32:33], v7 offset:32768
    ds_read_b64_tr_b16 v[34:35], v7 offset:33280
    ds_read_b64_tr_b16 v[36:37], v7 offset:33792
    v_mfma_f32_32x32x16_bf16 v[80:95], v[52:55], v[232:235], v[80:95]
    ds_read_b64_tr_b16 v[38:39], v7 offset:34304
    ds_read_b128 v[244:247], v9 offset:32768
    ds_read_b64_tr_b16 v[40:41], v7 offset:40960
    s_lshl_b32 s73, s56, 12
    v_mfma_f32_32x32x16_bf16 v[64:79], v[56:59], v[236:239], v[64:79]
    ds_read_b64_tr_b16 v[42:43], v7 offset:41472
    ds_read_b64_tr_b16 v[44:45], v7 offset:41984
    ds_read_b64_tr_b16 v[46:47], v7 offset:42496
    s_mov_b32 s76, s54
    s_add_u32 m0, s73, 65536
    s_lshl_b32 s74, s76, 16
    buffer_load_dwordx4 v6, s[32:35], s74 offen lds
    v_mfma_f32_32x32x16_bf16 v[80:95], v[60:63], v[236:239], v[80:95]
    s_add_u32 s76, s54, 1
    s_and_b32 s76, s76, 7
    s_add_u32 m0, s73, 66560
    s_lshl_b32 s74, s76, 16
    buffer_load_dwordx4 v6, s[32:35], s74 offen lds
    s_waitcnt lgkmcnt(5)
    v_mfma_f32_32x32x16_bf16 v[64:79], v[32:35], v[240:243], v[64:79]
    ds_read_b128 v[248:251], v10 offset:32768
    ds_read_b64_tr_b16 v[48:49], v7 offset:49152
    ds_read_b64_tr_b16 v[50:51], v7 offset:49664
    ds_read_b64_tr_b16 v[52:53], v7 offset:50176
    v_mfma_f32_32x32x16_bf16 v[80:95], v[36:39], v[240:243], v[80:95]
    ds_read_b64_tr_b16 v[54:55], v7 offset:50688
    ds_read_b128 v[252:255], v11 offset:32768
    ds_read_b64_tr_b16 v[56:57], v7 offset:57344
    s_waitcnt lgkmcnt(7)
    v_mfma_f32_32x32x16_bf16 v[64:79], v[40:43], v[244:247], v[64:79]
    ds_read_b64_tr_b16 v[58:59], v7 offset:57856
    ds_read_b64_tr_b16 v[60:61], v7 offset:58368
    ds_read_b64_tr_b16 v[62:63], v7 offset:58880
    s_add_u32 s76, s54, 2
    s_and_b32 s76, s76, 7
    s_add_u32 m0, s73, 67584
    s_lshl_b32 s74, s76, 16
    buffer_load_dwordx4 v6, s[32:35], s74 offen lds
    v_mfma_f32_32x32x16_bf16 v[80:95], v[44:47], v[244:247], v[80:95]
    s_add_u32 s76, s54, 3
    s_and_b32 s76, s76, 7
    s_add_u32 m0, s73, 68608
    s_lshl_b32 s74, s76, 16
    buffer_load_dwordx4 v6, s[32:35], s74 offen lds
    v_xor_b32 v7, 0x10000, v7
    v_xor_b32 v8, 0x10000, v8
    v_xor_b32 v9, 0x10000, v9
    v_xor_b32 v10, 0x10000, v10
    v_xor_b32 v11, 0x10000, v11
    s_waitcnt lgkmcnt(0)
    v_mfma_f32_32x32x16_bf16 v[64:79], v[48:51], v[248:251], v[64:79]
    v_mfma_f32_32x32x16_bf16 v[80:95], v[52:55], v[248:251], v[80:95]
    v_mfma_f32_32x32x16_bf16 v[64:79], v[56:59], v[252:255], v[64:79]
    v_mfma_f32_32x32x16_bf16 v[80:95], v[60:63], v[252:255], v[80:95]
    s_barrier
    s_cmp_lg_u32 s52, 0
    s_cbranch_scc1 L_kepiB_6
    s_nop 7
    v_cvt_pk_bf16_f32 v40, v64, v65
    v_cvt_pk_bf16_f32 v41, v66, v67
    v_cvt_pk_bf16_f32 v42, v68, v69
    v_cvt_pk_bf16_f32 v43, v70, v71
    v_cvt_pk_bf16_f32 v44, v72, v73
    v_cvt_pk_bf16_f32 v45, v74, v75
    v_cvt_pk_bf16_f32 v46, v76, v77
    v_cvt_pk_bf16_f32 v47, v78, v79
    v_mfma_f32_32x32x16_bf16 v[48:63], v[112:115], v[40:43], 0
    s_nop 0
    v_mfma_f32_32x32x16_bf16 v[64:79], v[116:119], v[44:47], 0
    v_cvt_pk_bf16_f32 v32, v80, v81
    v_cvt_pk_bf16_f32 v33, v82, v83
    v_cvt_pk_bf16_f32 v34, v84, v85
    v_cvt_pk_bf16_f32 v35, v86, v87
    v_cvt_pk_bf16_f32 v36, v88, v89
    v_cvt_pk_bf16_f32 v37, v90, v91
    v_cvt_pk_bf16_f32 v38, v92, v93
    v_cvt_pk_bf16_f32 v39, v94, v95
    ds_write_b128 v12, v[32:35]
    ds_write_b128 v12, v[36:39] offset:8192
    buffer_load_dwordx4 v[112:115], v26, s[40:43], s91 offen
    buffer_load_dwordx4 v[116:119], v26, s[40:43], s91 offen offset:2048
    s_mov_b64 exec, 1
    buffer_load_dword v119, v26, s[36:39], s92 offen
    s_mov_b64 exec, -1
    v_xor_b32 v30, 16, v13
    v_max3_f32 v96, v48, v49, v50
    v_max3_f32 v97, v51, v52, v53
    v_max3_f32 v98, v54, v55, v56
    v_max3_f32 v99, v57, v58, v59
    v_max3_f32 v100, v60, v61, v62
    v_max3_f32 v104, v64, v65, v66
    v_max3_f32 v105, v67, v68, v69
    v_max3_f32 v106, v70, v71, v72
    v_max3_f32 v107, v73, v74, v75
    v_max3_f32 v108, v76, v77, v78
    v_max3_f32 v96, v96, v97, v63
    v_max3_f32 v98, v98, v99, v100
    v_max3_f32 v104, v104, v105, v79
    v_max3_f32 v106, v106, v107, v108
    v_max_f32 v96, v96, v98
    v_max_f32 v104, v104, v106
    v_mul_f32 v96, s62, v96
    v_mul_f32 v104, s62, v104
    v_pk_fma_f32 v[48:49], v[48:49], s[62:63], v[96:97] op_sel_hi:[1,0,0] neg_lo:[0,0,1] neg_hi:[0,0,1]
    v_pk_fma_f32 v[64:65], v[64:65], s[62:63], v[104:105] op_sel_hi:[1,0,0] neg_lo:[0,0,1] neg_hi:[0,0,1]
    v_pk_fma_f32 v[50:51], v[50:51], s[62:63], v[96:97] op_sel_hi:[1,0,0] neg_lo:[0,0,1] neg_hi:[0,0,1]
    v_pk_fma_f32 v[66:67], v[66:67], s[62:63], v[104:105] op_sel_hi:[1,0,0] neg_lo:[0,0,1] neg_hi:[0,0,1]
    v_pk_fma_f32 v[52:53], v[52:53], s[62:63], v[96:97] op_sel_hi:[1,0,0] neg_lo:[0,0,1] neg_hi:[0,0,1]
    v_pk_fma_f32 v[68:69], v[68:69], s[62:63], v[104:105] op_sel_hi:[1,0,0] neg_lo:[0,0,1] neg_hi:[0,0,1]
    v_pk_fma_f32 v[54:55], v[54:55], s[62:63], v[96:97] op_sel_hi:[1,0,0] neg_lo:[0,0,1] neg_hi:[0,0,1]
    v_pk_fma_f32 v[70:71], v[70:71], s[62:63], v[104:105] op_sel_hi:[1,0,0] neg_lo:[0,0,1] neg_hi:[0,0,1]
    v_pk_fma_f32 v[56:57], v[56:57], s[62:63], v[96:97] op_sel_hi:[1,0,0] neg_lo:[0,0,1] neg_hi:[0,0,1]
    v_pk_fma_f32 v[72:73], v[72:73], s[62:63], v[104:105] op_sel_hi:[1,0,0] neg_lo:[0,0,1] neg_hi:[0,0,1]
    v_pk_fma_f32 v[58:59], v[58:59], s[62:63], v[96:97] op_sel_hi:[1,0,0] neg_lo:[0,0,1] neg_hi:[0,0,1]
    v_pk_fma_f32 v[74:75], v[74:75], s[62:63], v[104:105] op_sel_hi:[1,0,0] neg_lo:[0,0,1] neg_hi:[0,0,1]
    v_pk_fma_f32 v[60:61], v[60:61], s[62:63], v[96:97] op_sel_hi:[1,0,0] neg_lo:[0,0,1] neg_hi:[0,0,1]
    v_pk_fma_f32 v[76:77], v[76:77], s[62:63], v[104:105] op_sel_hi:[1,0,0] neg_lo:[0,0,1] neg_hi:[0,0,1]
    v_pk_fma_f32 v[62:63], v[62:63], s[62:63], v[96:97] op_sel_hi:[1,0,0] neg_lo:[0,0,1] neg_hi:[0,0,1]
    v_pk_fma_f32 v[78:79], v[78:79], s[62:63], v[104:105] op_sel_hi:[1,0,0] neg_lo:[0,0,1] neg_hi:[0,0,1]
    v_exp_f32 v48, v48
    v_exp_f32 v49, v49
    v_exp_f32 v50, v50
    v_exp_f32 v51, v51
    v_exp_f32 v52, v52
    v_exp_f32 v53, v53
    v_exp_f32 v54, v54
    v_exp_f32 v55, v55
    v_exp_f32 v56, v56
    v_exp_f32 v57, v57
    v_exp_f32 v58, v58
    v_exp_f32 v59, v59
    v_exp_f32 v60, v60
    v_exp_f32 v61, v61
    v_exp_f32 v62, v62
    v_exp_f32 v63, v63
    v_exp_f32 v64, v64
    v_exp_f32 v65, v65
    v_exp_f32 v66, v66
    v_exp_f32 v67, v67
    v_exp_f32 v68, v68
    v_exp_f32 v69, v69
    v_exp_f32 v70, v70
    v_exp_f32 v71, v71
    v_exp_f32 v72, v72
    v_exp_f32 v73, v73
    v_exp_f32 v74, v74
    v_exp_f32 v75, v75
    v_exp_f32 v76, v76
    v_exp_f32 v77, v77
    v_exp_f32 v78, v78
    v_exp_f32 v79, v79
    v_pk_add_f32 v[96:97], v[48:49], v[50:51]
    v_pk_add_f32 v[98:99], v[52:53], v[54:55]
    v_pk_add_f32 v[100:101], v[56:57], v[58:59]
    v_pk_add_f32 v[102:103], v[60:61], v[62:63]
    v_pk_add_f32 v[104:105], v[64:65], v[66:67]
    v_pk_add_f32 v[106:107], v[68:69], v[70:71]
    v_pk_add_f32 v[108:109], v[72:73], v[74:75]
    v_pk_add_f32 v[110:111], v[76:77], v[78:79]
    v_pk_add_f32 v[96:97], v[96:97], v[98:99]
    v_pk_add_f32 v[100:101], v[100:101], v[102:103]
    v_pk_add_f32 v[104:105], v[104:105], v[106:107]
    v_pk_add_f32 v[108:109], v[108:109], v[110:111]
    v_pk_add_f32 v[96:97], v[96:97], v[100:101]
    v_pk_add_f32 v[104:105], v[104:105], v[108:109]
    v_add_f32 v96, v96, v97
    v_add_f32 v104, v104, v105
    v_rcp_f32 v96, v96
    v_rcp_f32 v104, v104
    v_pk_mul_f32 v[48:49], v[48:49], v[96:97] op_sel_hi:[1,0]
    v_pk_mul_f32 v[50:51], v[50:51], v[96:97] op_sel_hi:[1,0]
    v_pk_mul_f32 v[52:53], v[52:53], v[96:97] op_sel_hi:[1,0]
    v_pk_mul_f32 v[54:55], v[54:55], v[96:97] op_sel_hi:[1,0]
    v_pk_mul_f32 v[56:57], v[56:57], v[96:97] op_sel_hi:[1,0]
    v_pk_mul_f32 v[58:59], v[58:59], v[96:97] op_sel_hi:[1,0]
    v_pk_mul_f32 v[60:61], v[60:61], v[96:97] op_sel_hi:[1,0]
    v_pk_mul_f32 v[62:63], v[62:63], v[96:97] op_sel_hi:[1,0]
    v_cvt_pk_bf16_f32 v32, v48, v49
    v_cvt_pk_bf16_f32 v33, v50, v51
    v_cvt_pk_bf16_f32 v34, v52, v53
    v_cvt_pk_bf16_f32 v35, v54, v55
    v_cvt_pk_bf16_f32 v36, v56, v57
    v_cvt_pk_bf16_f32 v37, v58, v59
    v_cvt_pk_bf16_f32 v38, v60, v61
    v_cvt_pk_bf16_f32 v39, v62, v63
    ds_write_b128 v13, v[32:35] offset:0
    ds_write_b128 v30, v[36:39] offset:0
    v_pk_mul_f32 v[64:65], v[64:65], v[104:105] op_sel_hi:[1,0]
    v_pk_mul_f32 v[66:67], v[66:67], v[104:105] op_sel_hi:[1,0]
    v_pk_mul_f32 v[68:69], v[68:69], v[104:105] op_sel_hi:[1,0]
    v_pk_mul_f32 v[70:71], v[70:71], v[104:105] op_sel_hi:[1,0]
    v_pk_mul_f32 v[72:73], v[72:73], v[104:105] op_sel_hi:[1,0]
    v_pk_mul_f32 v[74:75], v[74:75], v[104:105] op_sel_hi:[1,0]
    v_pk_mul_f32 v[76:77], v[76:77], v[104:105] op_sel_hi:[1,0]
    v_pk_mul_f32 v[78:79], v[78:79], v[104:105] op_sel_hi:[1,0]
    v_cvt_pk_bf16_f32 v40, v64, v65
    v_cvt_pk_bf16_f32 v41, v66, v67
    v_cvt_pk_bf16_f32 v42, v68, v69
    v_cvt_pk_bf16_f32 v43, v70, v71
    v_cvt_pk_bf16_f32 v44, v72, v73
    v_cvt_pk_bf16_f32 v45, v74, v75
    v_cvt_pk_bf16_f32 v46, v76, v77
    v_cvt_pk_bf16_f32 v47, v78, v79
    ds_write_b128 v13, v[40:43] offset:8192
    ds_write_b128 v30, v[44:47] offset:8192
    s_branch L_kepiE_7
L_kepiB_6:
    s_nop 7
    s_nop 3
    v_cvt_pk_bf16_f32 v32, v80, v81
    v_cvt_pk_bf16_f32 v33, v82, v83
    v_cvt_pk_bf16_f32 v34, v84, v85
    v_cvt_pk_bf16_f32 v35, v86, v87
    v_cvt_pk_bf16_f32 v36, v88, v89
    v_cvt_pk_bf16_f32 v37, v90, v91
    v_cvt_pk_bf16_f32 v38, v92, v93
    v_cvt_pk_bf16_f32 v39, v94, v95
    ds_write_b128 v12, v[32:35]
    ds_write_b128 v12, v[36:39] offset:8192
    buffer_load_dwordx4 v[112:115], v26, s[40:43], s91 offen
    buffer_load_dwordx4 v[116:119], v26, s[40:43], s91 offen offset:2048
    s_mov_b64 exec, 1
    buffer_load_dword v119, v26, s[36:39], s92 offen
    s_mov_b64 exec, -1
    v_pk_mul_f32 v[96:97], v[64:65], s[62:63] op_sel_hi:[1,0]
    v_pk_mul_f32 v[98:99], v[66:67], s[62:63] op_sel_hi:[1,0]
    v_pk_mul_f32 v[100:101], v[68:69], s[62:63] op_sel_hi:[1,0]
    v_pk_mul_f32 v[102:103], v[70:71], s[62:63] op_sel_hi:[1,0]
    v_pk_mul_f32 v[104:105], v[72:73], s[62:63] op_sel_hi:[1,0]
    v_pk_mul_f32 v[106:107], v[74:75], s[62:63] op_sel_hi:[1,0]
    v_pk_mul_f32 v[108:109], v[76:77], s[62:63] op_sel_hi:[1,0]
    v_pk_mul_f32 v[110:111], v[78:79], s[62:63] op_sel_hi:[1,0]
    v_exp_f32 v96, v96
    v_exp_f32 v97, v97
    v_exp_f32 v98, v98
    v_exp_f32 v99, v99
    v_exp_f32 v100, v100
    v_exp_f32 v101, v101
    v_exp_f32 v102, v102
    v_exp_f32 v103, v103
    v_exp_f32 v104, v104
    v_exp_f32 v105, v105
    v_exp_f32 v106, v106
    v_exp_f32 v107, v107
    v_exp_f32 v108, v108
    v_exp_f32 v109, v109
    v_exp_f32 v110, v110
    v_exp_f32 v111, v111
    v_pk_add_f32 v[64:65], v[64:65], 1.0 op_sel_hi:[1,0]
    v_pk_add_f32 v[66:67], v[66:67], 1.0 op_sel_hi:[1,0]
    v_pk_add_f32 v[68:69], v[68:69], 1.0 op_sel_hi:[1,0]
    v_pk_add_f32 v[70:71], v[70:71], 1.0 op_sel_hi:[1,0]
    v_pk_add_f32 v[72:73], v[72:73], 1.0 op_sel_hi:[1,0]
    v_pk_add_f32 v[74:75], v[74:75], 1.0 op_sel_hi:[1,0]
    v_pk_add_f32 v[76:77], v[76:77], 1.0 op_sel_hi:[1,0]
    v_pk_add_f32 v[78:79], v[78:79], 1.0 op_sel_hi:[1,0]
    v_med3_f32 v64, v96, 1.0, v64
    v_med3_f32 v65, v97, 1.0, v65
    v_med3_f32 v66, v98, 1.0, v66
    v_med3_f32 v67, v99, 1.0, v67
    v_med3_f32 v68, v100, 1.0, v68
    v_med3_f32 v69, v101, 1.0, v69
    v_med3_f32 v70, v102, 1.0, v70
    v_med3_f32 v71, v103, 1.0, v71
    v_med3_f32 v72, v104, 1.0, v72
    v_med3_f32 v73, v105, 1.0, v73
    v_med3_f32 v74, v106, 1.0, v74
    v_med3_f32 v75, v107, 1.0, v75
    v_med3_f32 v76, v108, 1.0, v76
    v_med3_f32 v77, v109, 1.0, v77
    v_med3_f32 v78, v110, 1.0, v78
    v_med3_f32 v79, v111, 1.0, v79
    v_pk_add_f32 v[64:65], v[64:65], s[98:99] op_sel_hi:[1,0]
    v_pk_add_f32 v[66:67], v[66:67], s[98:99] op_sel_hi:[1,0]
    v_pk_add_f32 v[68:69], v[68:69], s[98:99] op_sel_hi:[1,0]
    v_pk_add_f32 v[70:71], v[70:71], s[98:99] op_sel_hi:[1,0]
    v_pk_add_f32 v[72:73], v[72:73], s[98:99] op_sel_hi:[1,0]
    v_pk_add_f32 v[74:75], v[74:75], s[98:99] op_sel_hi:[1,0]
    v_pk_add_f32 v[76:77], v[76:77], s[98:99] op_sel_hi:[1,0]
    v_pk_add_f32 v[78:79], v[78:79], s[98:99] op_sel_hi:[1,0]
    v_cvt_pk_bf16_f32 v40, v64, v65
    v_cvt_pk_bf16_f32 v41, v66, v67
    v_cvt_pk_bf16_f32 v42, v68, v69
    v_cvt_pk_bf16_f32 v43, v70, v71
    v_cvt_pk_bf16_f32 v44, v72, v73
    v_cvt_pk_bf16_f32 v45, v74, v75
    v_cvt_pk_bf16_f32 v46, v76, v77
    v_cvt_pk_bf16_f32 v47, v78, v79
    v_xor_b32 v30, 32, v13
    ds_write_b128 v13, v[40:43]
    ds_write_b128 v30, v[44:47]
L_kepiE_7:
    s_waitcnt vmcnt(4) lgkmcnt(0)
    s_barrier
    s_cmp_ge_u32 s56, 4
    s_cbranch_scc1 L_nokv_8
    ds_read_b64_tr_b16 v[32:33], v14 offset:0
    ds_read_b64_tr_b16 v[34:35], v15 offset:0
    ds_read_b64_tr_b16 v[36:37], v16 offset:0
    ds_read_b64_tr_b16 v[38:39], v17 offset:0
    ds_read_b64_tr_b16 v[40:41], v14 offset:1024
    ds_read_b64_tr_b16 v[42:43], v15 offset:1024
    ds_read_b64_tr_b16 v[44:45], v16 offset:1024
    ds_read_b64_tr_b16 v[46:47], v17 offset:1024
    ds_read_b64_tr_b16 v[64:65], v14 offset:2048
    ds_read_b64_tr_b16 v[66:67], v15 offset:2048
    ds_read_b64_tr_b16 v[68:69], v16 offset:2048
    ds_read_b64_tr_b16 v[70:71], v17 offset:2048
    s_waitcnt lgkmcnt(8)
    v_mfma_f32_32x32x16_bf16 v[48:63], v[32:35], v[36:39], 0
    ds_read_b64_tr_b16 v[72:73], v14 offset:3072
    ds_read_b64_tr_b16 v[74:75], v15 offset:3072
    ds_read_b64_tr_b16 v[76:77], v16 offset:3072
    ds_read_b64_tr_b16 v[78:79], v17 offset:3072
    s_waitcnt lgkmcnt(8)
    v_mfma_f32_32x32x16_bf16 v[48:63], v[40:43], v[44:47], v[48:63]
    ds_read_b64_tr_b16 v[32:33], v14 offset:4096
    ds_read_b64_tr_b16 v[34:35], v15 offset:4096
    ds_read_b64_tr_b16 v[36:37], v16 offset:4096
    ds_read_b64_tr_b16 v[38:39], v17 offset:4096
    s_waitcnt lgkmcnt(8)
    v_mfma_f32_32x32x16_bf16 v[48:63], v[64:67], v[68:71], v[48:63]
    ds_read_b64_tr_b16 v[40:41], v14 offset:5120
    ds_read_b64_tr_b16 v[42:43], v15 offset:5120
    ds_read_b64_tr_b16 v[44:45], v16 offset:5120
    ds_read_b64_tr_b16 v[46:47], v17 offset:5120
    s_waitcnt lgkmcnt(8)
    v_mfma_f32_32x32x16_bf16 v[48:63], v[72:75], v[76:79], v[48:63]
    ds_read_b64_tr_b16 v[64:65], v14 offset:6144
    ds_read_b64_tr_b16 v[66:67], v15 offset:6144
    ds_read_b64_tr_b16 v[68:69], v16 offset:6144
    ds_read_b64_tr_b16 v[70:71], v17 offset:6144
    s_waitcnt lgkmcnt(8)
    v_mfma_f32_32x32x16_bf16 v[48:63], v[32:35], v[36:39], v[48:63]
    ds_read_b64_tr_b16 v[72:73], v14 offset:7168
    ds_read_b64_tr_b16 v[74:75], v15 offset:7168
    ds_read_b64_tr_b16 v[76:77], v16 offset:7168
    ds_read_b64_tr_b16 v[78:79], v17 offset:7168
    s_waitcnt lgkmcnt(8)
    v_mfma_f32_32x32x16_bf16 v[48:63], v[40:43], v[44:47], v[48:63]
    s_waitcnt lgkmcnt(4)
    v_mfma_f32_32x32x16_bf16 v[48:63], v[64:67], v[68:71], v[48:63]
    s_waitcnt lgkmcnt(0)
    v_mfma_f32_32x32x16_bf16 v[48:63], v[72:75], v[76:79], v[48:63]
    s_lshl_b32 s64, s52, 3
    s_add_u32 s64, s64, s54
    s_lshl_b32 s64, s64, 2
    s_add_u32 s64, s64, s56
    s_lshl_b32 s64, s64, 15
    s_add_u32 s64, s64, 262144
    v_and_b32 v30, 1, v1
    v_cmp_eq_u32 vcc, 1, v30
    v_mov_b32 v96, 0
    v_mov_b32 v97, 0
    v_mov_b32 v98, 0
    v_mov_b32 v99, 0
    v_mov_b32 v100, 0
    v_mov_b32 v101, 0
    v_mov_b32 v102, 0
    v_mov_b32 v103, 0
    v_mov_b32 v82, s59
    v_mov_b32 v86, s59
    v_mov_b32 v90, s59
    v_mov_b32 v94, s59
    s_cmp_lg_u32 s52, 0
    s_cbranch_scc1 L_pubB_9
    v_cvt_pk_bf16_f32 v80, v48, v49
    v_cvt_pk_bf16_f32 v81, v50, v51
    v_cvt_pk_bf16_f32 v84, v52, v53
    v_cvt_pk_bf16_f32 v85, v54, v55
    v_cvt_pk_bf16_f32 v88, v56, v57
    v_cvt_pk_bf16_f32 v89, v58, v59
    v_cvt_pk_bf16_f32 v92, v60, v61
    v_cvt_pk_bf16_f32 v93, v62, v63
    v_permlane16_swap_b32 v80, v96
    v_permlane16_swap_b32 v81, v97
    v_permlane16_swap_b32 v84, v98
    v_permlane16_swap_b32 v85, v99
    v_permlane16_swap_b32 v88, v100
    v_permlane16_swap_b32 v89, v101
    v_permlane16_swap_b32 v92, v102
    v_permlane16_swap_b32 v93, v103
    v_cndmask_b32 v83, v96, v97, vcc
    v_cndmask_b32 v87, v98, v99, vcc
    v_cndmask_b32 v91, v100, v101, vcc
    v_cndmask_b32 v95, v102, v103, vcc
    s_branch L_pubS_10
L_pubB_9:
    s_nop 7
    s_bitcmp1_b32 s56, 0
    s_cbranch_scc1 L_pubBodd_11
    v_cvt_pk_bf16_f32 v80, v48, v49
    v_cvt_pk_bf16_f32 v84, v50, v51
    v_cvt_pk_bf16_f32 v88, v52, v53
    v_cvt_pk_bf16_f32 v92, v54, v55
    s_branch L_pubBd_12
L_pubBodd_11:
    v_cvt_pk_bf16_f32 v80, v56, v57
    v_cvt_pk_bf16_f32 v84, v58, v59
    v_cvt_pk_bf16_f32 v88, v60, v61
    v_cvt_pk_bf16_f32 v92, v62, v63
L_pubBd_12:
    v_mov_b32 v83, 0
    v_mov_b32 v81, 0
    v_mov_b32 v87, 0
    v_mov_b32 v85, 0
    v_mov_b32 v91, 0
    v_mov_b32 v89, 0
    v_mov_b32 v95, 0
    v_mov_b32 v93, 0
    v_permlane16_swap_b32 v80, v83
    v_permlane16_swap_b32 v84, v87
    v_permlane16_swap_b32 v88, v91
    v_permlane16_swap_b32 v92, v95
L_pubS_10:
    s_mov_b32 exec_lo, 0xffff
    s_mov_b32 exec_hi, 0xffff
    s_add_u32 s65, s64, 0
    buffer_store_dwordx4 v[80:83], v18, s[36:39], s65 offen sc1
    s_add_u32 s65, s64, 8192
    buffer_store_dwordx4 v[84:87], v18, s[36:39], s65 offen sc1
    s_add_u32 s65, s64, 16384
    buffer_store_dwordx4 v[88:91], v18, s[36:39], s65 offen sc1
    s_add_u32 s65, s64, 24576
    buffer_store_dwordx4 v[92:95], v18, s[36:39], s65 offen sc1
    s_mov_b64 exec, -1
L_nokv_8:
    s_lshl_b32 s78, s52, 3
    s_add_u32 s78, s78, s54
    s_lshl_b32 s78, s78, 4
    s_add_u32 s78, s78, s53
    s_lshl_b32 s79, s78, 13
    s_add_u32 s79, s79, 262144
    s_lshl_b32 s80, s78, 9
    s_add_u32 s80, s80, 65536
    ds_read_b64_tr_b16 v[32:33], v7 offset:0
    ds_read_b64_tr_b16 v[34:35], v7 offset:512
    ds_read_b64_tr_b16 v[36:37], v7 offset:8192
    ds_read_b64_tr_b16 v[38:39], v7 offset:8704
    ds_read_b64_tr_b16 v[40:41], v7 offset:16384
    ds_read_b64_tr_b16 v[42:43], v7 offset:16896
    ds_read_b64_tr_b16 v[44:45], v7 offset:24576
    ds_read_b64_tr_b16 v[46:47], v7 offset:25088
    s_waitcnt lgkmcnt(6)
    v_mfma_f32_32x32x16_bf16 v[64:79], v[32:35], v[128:131], 0
    ds_read_b64_tr_b16 v[48:49], v7 offset:1024
    ds_read_b64_tr_b16 v[50:51], v7 offset:1536
    s_waitcnt lgkmcnt(6)
    v_mfma_f32_32x32x16_bf16 v[64:79], v[36:39], v[132:135], v[64:79]
    ds_read_b64_tr_b16 v[52:53], v7 offset:9216
    ds_read_b64_tr_b16 v[54:55], v7 offset:9728
    s_waitcnt lgkmcnt(6)
    v_mfma_f32_32x32x16_bf16 v[64:79], v[40:43], v[136:139], v[64:79]
    ds_read_b64_tr_b16 v[56:57], v7 offset:17408
    ds_read_b64_tr_b16 v[58:59], v7 offset:17920
    s_waitcnt lgkmcnt(6)
    v_mfma_f32_32x32x16_bf16 v[64:79], v[44:47], v[140:143], v[64:79]
    ds_read_b64_tr_b16 v[60:61], v7 offset:25600
    ds_read_b64_tr_b16 v[62:63], v7 offset:26112
    s_waitcnt lgkmcnt(6)
    v_mfma_f32_32x32x16_bf16 v[64:79], v[48:51], v[144:147], v[64:79]
    ds_read_b64_tr_b16 v[32:33], v7 offset:2048
    ds_read_b64_tr_b16 v[34:35], v7 offset:2560
    s_waitcnt lgkmcnt(6)
    v_mfma_f32_32x32x16_bf16 v[64:79], v[52:55], v[148:151], v[64:79]
    ds_read_b64_tr_b16 v[36:37], v7 offset:10240
    ds_read_b64_tr_b16 v[38:39], v7 offset:10752
    s_waitcnt lgkmcnt(6)
    v_mfma_f32_32x32x16_bf16 v[64:79], v[56:59], v[152:155], v[64:79]
    ds_read_b64_tr_b16 v[40:41], v7 offset:18432
    ds_read_b64_tr_b16 v[42:43], v7 offset:18944
    s_waitcnt lgkmcnt(6)
    v_mfma_f32_32x32x16_bf16 v[64:79], v[60:63], v[156:159], v[64:79]
    ds_read_b64_tr_b16 v[44:45], v7 offset:26624
    ds_read_b64_tr_b16 v[46:47], v7 offset:27136
    s_waitcnt lgkmcnt(6)
    v_mfma_f32_32x32x16_bf16 v[64:79], v[32:35], v[160:163], v[64:79]
    ds_read_b64_tr_b16 v[48:49], v7 offset:3072
    ds_read_b64_tr_b16 v[50:51], v7 offset:3584
    s_waitcnt lgkmcnt(6)
    v_mfma_f32_32x32x16_bf16 v[64:79], v[36:39], v[164:167], v[64:79]
    ds_read_b64_tr_b16 v[52:53], v7 offset:11264
    ds_read_b64_tr_b16 v[54:55], v7 offset:11776
    s_waitcnt lgkmcnt(6)
    v_mfma_f32_32x32x16_bf16 v[64:79], v[40:43], v[168:171], v[64:79]
    ds_read_b64_tr_b16 v[56:57], v7 offset:19456
    ds_read_b64_tr_b16 v[58:59], v7 offset:19968
    s_waitcnt lgkmcnt(6)
    v_mfma_f32_32x32x16_bf16 v[64:79], v[44:47], v[172:175], v[64:79]
    ds_read_b64_tr_b16 v[60:61], v7 offset:27648
    ds_read_b64_tr_b16 v[62:63], v7 offset:28160
    s_waitcnt lgkmcnt(6)
    v_mfma_f32_32x32x16_bf16 v[64:79], v[48:51], v[176:179], v[64:79]
    ds_read_b64_tr_b16 v[32:33], v7 offset:32768
    ds_read_b64_tr_b16 v[34:35], v7 offset:33280
    s_waitcnt lgkmcnt(6)
    v_mfma_f32_32x32x16_bf16 v[64:79], v[52:55], v[180:183], v[64:79]
    ds_read_b64_tr_b16 v[36:37], v7 offset:40960
    ds_read_b64_tr_b16 v[38:39], v7 offset:41472
    s_waitcnt lgkmcnt(6)
    v_mfma_f32_32x32x16_bf16 v[64:79], v[56:59], v[184:187], v[64:79]
    ds_read_b64_tr_b16 v[40:41], v7 offset:49152
    ds_read_b64_tr_b16 v[42:43], v7 offset:49664
    s_waitcnt lgkmcnt(6)
    v_mfma_f32_32x32x16_bf16 v[64:79], v[60:63], v[188:191], v[64:79]
    ds_read_b64_tr_b16 v[44:45], v7 offset:57344
    ds_read_b64_tr_b16 v[46:47], v7 offset:57856
    s_waitcnt lgkmcnt(6)
    v_mfma_f32_32x32x16_bf16 v[64:79], v[32:35], v[192:195], v[64:79]
    ds_read_b64_tr_b16 v[48:49], v7 offset:33792
    ds_read_b64_tr_b16 v[50:51], v7 offset:34304
    s_waitcnt lgkmcnt(6)
    v_mfma_f32_32x32x16_bf16 v[64:79], v[36:39], v[196:199], v[64:79]
    ds_read_b64_tr_b16 v[52:53], v7 offset:41984
    ds_read_b64_tr_b16 v[54:55], v7 offset:42496
    s_waitcnt lgkmcnt(6)
    v_mfma_f32_32x32x16_bf16 v[64:79], v[40:43], v[200:203], v[64:79]
    ds_read_b64_tr_b16 v[56:57], v7 offset:50176
    ds_read_b64_tr_b16 v[58:59], v7 offset:50688
    s_waitcnt lgkmcnt(6)
    v_mfma_f32_32x32x16_bf16 v[64:79], v[44:47], v[204:207], v[64:79]
    ds_read_b64_tr_b16 v[60:61], v7 offset:58368
    ds_read_b64_tr_b16 v[62:63], v7 offset:58880
    s_waitcnt lgkmcnt(6)
    v_mfma_f32_32x32x16_bf16 v[64:79], v[48:51], v[208:211], v[64:79]
    ds_read_b64_tr_b16 v[32:33], v7 offset:34816
    ds_read_b64_tr_b16 v[34:35], v7 offset:35328
    s_waitcnt lgkmcnt(6)
    v_mfma_f32_32x32x16_bf16 v[64:79], v[52:55], v[212:215], v[64:79]
    ds_read_b64_tr_b16 v[36:37], v7 offset:43008
    ds_read_b64_tr_b16 v[38:39], v7 offset:43520
    s_waitcnt lgkmcnt(6)
    v_mfma_f32_32x32x16_bf16 v[64:79], v[56:59], v[216:219], v[64:79]
    ds_read_b64_tr_b16 v[40:41], v7 offset:51200
    ds_read_b64_tr_b16 v[42:43], v7 offset:51712
    s_waitcnt lgkmcnt(6)
    v_mfma_f32_32x32x16_bf16 v[64:79], v[60:63], v[220:223], v[64:79]
    ds_read_b64_tr_b16 v[44:45], v7 offset:59392
    ds_read_b64_tr_b16 v[46:47], v7 offset:59904
    buffer_load_dwordx4 v[96:99], v19, s[36:39], s79 offen sc1
    s_waitcnt lgkmcnt(6)
    v_mfma_f32_32x32x16_bf16 v[64:79], v[32:35], v[224:227], v[64:79]
    ds_read_b64_tr_b16 v[48:49], v7 offset:35840
    ds_read_b64_tr_b16 v[50:51], v7 offset:36352
    s_waitcnt lgkmcnt(6)
    v_mfma_f32_32x32x16_bf16 v[64:79], v[36:39], v[228:231], v[64:79]
    ds_read_b64_tr_b16 v[52:53], v7 offset:44032
    ds_read_b64_tr_b16 v[54:55], v7 offset:44544
    s_waitcnt lgkmcnt(6)
    v_mfma_f32_32x32x16_bf16 v[64:79], v[40:43], v[232:235], v[64:79]
    ds_read_b64_tr_b16 v[56:57], v7 offset:52224
    ds_read_b64_tr_b16 v[58:59], v7 offset:52736
    s_waitcnt lgkmcnt(6)
    v_mfma_f32_32x32x16_bf16 v[64:79], v[44:47], v[236:239], v[64:79]
    ds_read_b64_tr_b16 v[60:61], v7 offset:60416
    ds_read_b64_tr_b16 v[62:63], v7 offset:60928
    s_waitcnt lgkmcnt(6)
    v_mfma_f32_32x32x16_bf16 v[64:79], v[48:51], v[240:243], v[64:79]
    s_waitcnt lgkmcnt(4)
    v_mfma_f32_32x32x16_bf16 v[64:79], v[52:55], v[244:247], v[64:79]
    s_waitcnt lgkmcnt(2)
    v_mfma_f32_32x32x16_bf16 v[64:79], v[56:59], v[248:251], v[64:79]
    s_waitcnt lgkmcnt(0)
    v_mfma_f32_32x32x16_bf16 v[64:79], v[60:63], v[252:255], v[64:79]
    s_mov_b32 s84, 0
L_h1a_poll_13:
    s_waitcnt vmcnt(0)
    v_cmp_ne_u32 vcc, s59, v98
    s_cbranch_vccz L_h1a_done_14
    s_add_u32 s84, s84, 1
    s_cmp_lt_u32 s84, 100000
    s_cbranch_scc0 L_h1a_done_14
    s_sleep 4
    buffer_load_dwordx4 v[96:99], v19, s[36:39], s79 offen sc1
    s_branch L_h1a_poll_13
L_h1a_done_14:
    v_lshlrev_b32 v100, 16, v96
    v_and_b32 v101, 0xffff0000, v96
    v_lshlrev_b32 v102, 16, v97
    v_and_b32 v103, 0xffff0000, v97
    v_lshlrev_b32 v104, 16, v99
    v_and_b32 v105, 0xffff0000, v99
    v_add_f32_dpp v100, v100, v100 row_ror:4 row_mask:0xf bank_mask:0xf
    v_add_f32_dpp v101, v101, v101 row_ror:4 row_mask:0xf bank_mask:0xf
    v_add_f32_dpp v102, v102, v102 row_ror:4 row_mask:0xf bank_mask:0xf
    v_add_f32_dpp v103, v103, v103 row_ror:4 row_mask:0xf bank_mask:0xf
    v_add_f32_dpp v104, v104, v104 row_ror:4 row_mask:0xf bank_mask:0xf
    v_add_f32_dpp v105, v105, v105 row_ror:4 row_mask:0xf bank_mask:0xf
    v_add_f32_dpp v100, v100, v100 row_ror:8 row_mask:0xf bank_mask:0xf
    v_add_f32_dpp v101, v101, v101 row_ror:8 row_mask:0xf bank_mask:0xf
    v_add_f32_dpp v102, v102, v102 row_ror:8 row_mask:0xf bank_mask:0xf
    v_add_f32_dpp v103, v103, v103 row_ror:8 row_mask:0xf bank_mask:0xf
    v_add_f32_dpp v104, v104, v104 row_ror:8 row_mask:0xf bank_mask:0xf
    v_add_f32_dpp v105, v105, v105 row_ror:8 row_mask:0xf bank_mask:0xf
    v_mov_b32 v106, v100
    v_mov_b32 v107, v101
    v_mov_b32 v108, v102
    v_mov_b32 v109, v103
    v_mov_b32 v110, v104
    v_mov_b32 v111, v105
    v_permlane16_swap_b32 v100, v106
    v_permlane16_swap_b32 v101, v107
    v_permlane16_swap_b32 v102, v108
    v_permlane16_swap_b32 v103, v109
    v_permlane16_swap_b32 v104, v110
    v_permlane16_swap_b32 v105, v111
    v_add_f32 v100, v100, v106
    v_add_f32 v101, v101, v107
    v_add_f32 v102, v102, v108
    v_add_f32 v103, v103, v109
    v_add_f32 v104, v104, v110
    v_add_f32 v105, v105, v111
    v_mov_b32 v106, v100
    v_mov_b32 v107, v101
    v_mov_b32 v108, v102
    v_mov_b32 v109, v103
    v_mov_b32 v110, v104
    v_mov_b32 v111, v105
    v_permlane32_swap_b32 v100, v106
    v_permlane32_swap_b32 v101, v107
    v_permlane32_swap_b32 v102, v108
    v_permlane32_swap_b32 v103, v109
    v_permlane32_swap_b32 v104, v110
    v_permlane32_swap_b32 v105, v111
    v_add_f32 v100, v100, v106
    v_add_f32 v101, v101, v107
    v_add_f32 v102, v102, v108
    v_add_f32 v103, v103, v109
    v_add_f32 v104, v104, v110
    v_add_f32 v105, v105, v111
    v_cvt_pk_bf16_f32 v96, v100, v101
    v_cvt_pk_bf16_f32 v97, v102, v103
    v_cvt_pk_bf16_f32 v99, v104, v105
    s_mov_b32 exec_lo, 0xf
    s_mov_b32 exec_hi, 0
    buffer_store_dwordx4 v[96:99], v20, s[36:39], s80 offen sc1
    s_mov_b64 exec, -1
    s_barrier
    s_lshl_b32 s73, s56, 12
    s_add_u32 s76, s54, 4
    s_and_b32 s76, s76, 7
    s_add_u32 m0, s73, 98304
    s_lshl_b32 s74, s76, 16
    buffer_load_dwordx4 v6, s[32:35], s74 offen lds
    s_add_u32 s76, s54, 5
    s_and_b32 s76, s76, 7
    s_add_u32 m0, s73, 99328
    s_lshl_b32 s74, s76, 16
    buffer_load_dwordx4 v6, s[32:35], s74 offen lds
    s_add_u32 s76, s54, 6
    s_and_b32 s76, s76, 7
    s_add_u32 m0, s73, 100352
    s_lshl_b32 s74, s76, 16
    buffer_load_dwordx4 v6, s[32:35], s74 offen lds
    s_add_u32 s76, s54, 7
    s_and_b32 s76, s76, 7
    s_add_u32 m0, s73, 101376
    s_lshl_b32 s74, s76, 16
    buffer_load_dwordx4 v6, s[32:35], s74 offen lds
    s_lshl_b32 s81, s52, 3
    s_add_u32 s81, s81, s54
    s_lshl_b32 s81, s81, 13
    s_add_u32 s81, s81, 65536
    v_and_b32 v92, 7, v1
    v_lshlrev_b32 v92, 7, v92
    buffer_load_dword v93, v92, s[36:39], s85 offen sc1
    v_xor_b32 v7, 0x10000, v7
    s_cmp_lg_u32 s52, 0
    s_cbranch_scc1 L_qepiB_15
    v_cvt_pk_bf16_f32 v80, v64, v65
    v_cvt_pk_bf16_f32 v81, v66, v67
    v_cvt_pk_bf16_f32 v82, v68, v69
    v_cvt_pk_bf16_f32 v83, v70, v71
    v_cvt_pk_bf16_f32 v84, v72, v73
    v_cvt_pk_bf16_f32 v85, v74, v75
    v_cvt_pk_bf16_f32 v86, v76, v77
    v_cvt_pk_bf16_f32 v87, v78, v79
    v_mfma_f32_32x32x16_bf16 v[48:63], v[120:123], v[80:83], 0
    s_nop 0
    v_mfma_f32_32x32x16_bf16 v[64:79], v[124:127], v[84:87], 0
    s_nop 9
    v_max3_f32 v96, v48, v49, v50
    v_max3_f32 v97, v51, v52, v53
    v_max3_f32 v98, v54, v55, v56
    v_max3_f32 v99, v57, v58, v59
    ds_read_b64_tr_b16 v[128:129], v7 offset:0
    v_max3_f32 v100, v60, v61, v62
    v_max3_f32 v104, v64, v65, v66
    ds_read_b64_tr_b16 v[130:131], v7 offset:512
    v_max3_f32 v105, v67, v68, v69
    v_max3_f32 v106, v70, v71, v72
    ds_read_b64_tr_b16 v[132:133], v7 offset:8192
    v_max3_f32 v107, v73, v74, v75
    v_max3_f32 v108, v76, v77, v78
    ds_read_b64_tr_b16 v[134:135], v7 offset:8704
    v_max3_f32 v96, v96, v97, v63
    v_max3_f32 v98, v98, v99, v100
    ds_read_b64_tr_b16 v[136:137], v7 offset:16384
    v_max3_f32 v104, v104, v105, v79
    v_max3_f32 v106, v106, v107, v108
    ds_read_b64_tr_b16 v[138:139], v7 offset:16896
    v_max_f32 v96, v96, v98
    v_max_f32 v104, v104, v106
    ds_read_b64_tr_b16 v[140:141], v7 offset:24576
    v_mul_f32 v96, s62, v96
    v_mul_f32 v104, s62, v104
    ds_read_b64_tr_b16 v[142:143], v7 offset:25088
    s_waitcnt lgkmcnt(4)
    v_pk_fma_f32 v[48:49], v[48:49], s[62:63], v[96:97] op_sel_hi:[1,0,0] neg_lo:[0,0,1] neg_hi:[0,0,1]
    v_pk_fma_f32 v[64:65], v[64:65], s[62:63], v[104:105] op_sel_hi:[1,0,0] neg_lo:[0,0,1] neg_hi:[0,0,1]
    ds_read_b64_tr_b16 v[144:145], v7 offset:1024
    v_pk_fma_f32 v[50:51], v[50:51], s[62:63], v[96:97] op_sel_hi:[1,0,0] neg_lo:[0,0,1] neg_hi:[0,0,1]
    v_pk_fma_f32 v[66:67], v[66:67], s[62:63], v[104:105] op_sel_hi:[1,0,0] neg_lo:[0,0,1] neg_hi:[0,0,1]
    ds_read_b64_tr_b16 v[146:147], v7 offset:1536
    v_pk_fma_f32 v[52:53], v[52:53], s[62:63], v[96:97] op_sel_hi:[1,0,0] neg_lo:[0,0,1] neg_hi:[0,0,1]
    v_pk_fma_f32 v[68:69], v[68:69], s[62:63], v[104:105] op_sel_hi:[1,0,0] neg_lo:[0,0,1] neg_hi:[0,0,1]
    ds_read_b64_tr_b16 v[148:149], v7 offset:9216
    v_pk_fma_f32 v[54:55], v[54:55], s[62:63], v[96:97] op_sel_hi:[1,0,0] neg_lo:[0,0,1] neg_hi:[0,0,1]
    v_pk_fma_f32 v[70:71], v[70:71], s[62:63], v[104:105] op_sel_hi:[1,0,0] neg_lo:[0,0,1] neg_hi:[0,0,1]
    ds_read_b64_tr_b16 v[150:151], v7 offset:9728
    v_pk_fma_f32 v[56:57], v[56:57], s[62:63], v[96:97] op_sel_hi:[1,0,0] neg_lo:[0,0,1] neg_hi:[0,0,1]
    v_pk_fma_f32 v[72:73], v[72:73], s[62:63], v[104:105] op_sel_hi:[1,0,0] neg_lo:[0,0,1] neg_hi:[0,0,1]
    ds_read_b64_tr_b16 v[152:153], v7 offset:17408
    v_pk_fma_f32 v[58:59], v[58:59], s[62:63], v[96:97] op_sel_hi:[1,0,0] neg_lo:[0,0,1] neg_hi:[0,0,1]
    v_pk_fma_f32 v[74:75], v[74:75], s[62:63], v[104:105] op_sel_hi:[1,0,0] neg_lo:[0,0,1] neg_hi:[0,0,1]
    ds_read_b64_tr_b16 v[154:155], v7 offset:17920
    v_pk_fma_f32 v[60:61], v[60:61], s[62:63], v[96:97] op_sel_hi:[1,0,0] neg_lo:[0,0,1] neg_hi:[0,0,1]
    v_pk_fma_f32 v[76:77], v[76:77], s[62:63], v[104:105] op_sel_hi:[1,0,0] neg_lo:[0,0,1] neg_hi:[0,0,1]
    ds_read_b64_tr_b16 v[156:157], v7 offset:25600
    v_pk_fma_f32 v[62:63], v[62:63], s[62:63], v[96:97] op_sel_hi:[1,0,0] neg_lo:[0,0,1] neg_hi:[0,0,1]
    v_pk_fma_f32 v[78:79], v[78:79], s[62:63], v[104:105] op_sel_hi:[1,0,0] neg_lo:[0,0,1] neg_hi:[0,0,1]
    ds_read_b64_tr_b16 v[158:159], v7 offset:26112
    s_waitcnt lgkmcnt(4)
    v_exp_f32 v48, v48
    v_exp_f32 v49, v49
    ds_read_b64_tr_b16 v[160:161], v7 offset:2048
    v_exp_f32 v50, v50
    v_exp_f32 v51, v51
    ds_read_b64_tr_b16 v[162:163], v7 offset:2560
    v_exp_f32 v52, v52
    v_exp_f32 v53, v53
    ds_read_b64_tr_b16 v[164:165], v7 offset:10240
    v_exp_f32 v54, v54
    v_exp_f32 v55, v55
    ds_read_b64_tr_b16 v[166:167], v7 offset:10752
    v_exp_f32 v56, v56
    v_exp_f32 v57, v57
    ds_read_b64_tr_b16 v[168:169], v7 offset:18432
    v_exp_f32 v58, v58
    v_exp_f32 v59, v59
    ds_read_b64_tr_b16 v[170:171], v7 offset:18944
    v_exp_f32 v60, v60
    v_exp_f32 v61, v61
    ds_read_b64_tr_b16 v[172:173], v7 offset:26624
    v_exp_f32 v62, v62
    v_exp_f32 v63, v63
    ds_read_b64_tr_b16 v[174:175], v7 offset:27136
    s_waitcnt lgkmcnt(4)
    buffer_load_dwordx4 v[88:91], v29, s[36:39], s81 offen sc1
    v_exp_f32 v64, v64
    v_exp_f32 v65, v65
    ds_read_b64_tr_b16 v[176:177], v7 offset:3072
    v_exp_f32 v66, v66
    v_exp_f32 v67, v67
    ds_read_b64_tr_b16 v[178:179], v7 offset:3584
    v_exp_f32 v68, v68
    v_exp_f32 v69, v69
    ds_read_b64_tr_b16 v[180:181], v7 offset:11264
    v_exp_f32 v70, v70
    v_exp_f32 v71, v71
    ds_read_b64_tr_b16 v[182:183], v7 offset:11776
    v_exp_f32 v72, v72
    v_exp_f32 v73, v73
    ds_read_b64_tr_b16 v[184:185], v7 offset:19456
    v_exp_f32 v74, v74
    v_exp_f32 v75, v75
    ds_read_b64_tr_b16 v[186:187], v7 offset:19968
    v_exp_f32 v76, v76
    v_exp_f32 v77, v77
    ds_read_b64_tr_b16 v[188:189], v7 offset:27648
    v_exp_f32 v78, v78
    v_exp_f32 v79, v79
    ds_read_b64_tr_b16 v[190:191], v7 offset:28160
    s_waitcnt lgkmcnt(4)
    v_pk_add_f32 v[96:97], v[48:49], v[50:51]
    v_pk_add_f32 v[98:99], v[52:53], v[54:55]
    v_pk_add_f32 v[100:101], v[56:57], v[58:59]
    v_pk_add_f32 v[102:103], v[60:61], v[62:63]
    v_pk_add_f32 v[104:105], v[64:65], v[66:67]
    v_pk_add_f32 v[106:107], v[68:69], v[70:71]
    v_pk_add_f32 v[108:109], v[72:73], v[74:75]
    v_pk_add_f32 v[110:111], v[76:77], v[78:79]
    v_pk_add_f32 v[96:97], v[96:97], v[98:99]
    v_pk_add_f32 v[100:101], v[100:101], v[102:103]
    v_pk_add_f32 v[104:105], v[104:105], v[106:107]
    v_pk_add_f32 v[108:109], v[108:109], v[110:111]
    v_pk_add_f32 v[96:97], v[96:97], v[100:101]
    v_pk_add_f32 v[104:105], v[104:105], v[108:109]
    v_add_f32 v96, v96, v97
    v_add_f32 v104, v104, v105
    v_rcp_f32 v96, v96
    v_rcp_f32 v104, v104
    v_pk_mul_f32 v[48:49], v[48:49], v[96:97] op_sel_hi:[1,0]
    v_pk_mul_f32 v[50:51], v[50:51], v[96:97] op_sel_hi:[1,0]
    v_pk_mul_f32 v[52:53], v[52:53], v[96:97] op_sel_hi:[1,0]
    v_pk_mul_f32 v[54:55], v[54:55], v[96:97] op_sel_hi:[1,0]
    v_pk_mul_f32 v[56:57], v[56:57], v[96:97] op_sel_hi:[1,0]
    v_pk_mul_f32 v[58:59], v[58:59], v[96:97] op_sel_hi:[1,0]
    v_pk_mul_f32 v[60:61], v[60:61], v[96:97] op_sel_hi:[1,0]
    v_pk_mul_f32 v[62:63], v[62:63], v[96:97] op_sel_hi:[1,0]
    v_cvt_pk_bf16_f32 v32, v48, v49
    v_cvt_pk_bf16_f32 v33, v50, v51
    v_cvt_pk_bf16_f32 v34, v52, v53
    v_cvt_pk_bf16_f32 v35, v54, v55
    v_cvt_pk_bf16_f32 v36, v56, v57
    v_cvt_pk_bf16_f32 v37, v58, v59
    v_cvt_pk_bf16_f32 v38, v60, v61
    v_cvt_pk_bf16_f32 v39, v62, v63
    v_pk_mul_f32 v[64:65], v[64:65], v[104:105] op_sel_hi:[1,0]
    v_pk_mul_f32 v[66:67], v[66:67], v[104:105] op_sel_hi:[1,0]
    v_pk_mul_f32 v[68:69], v[68:69], v[104:105] op_sel_hi:[1,0]
    v_pk_mul_f32 v[70:71], v[70:71], v[104:105] op_sel_hi:[1,0]
    v_pk_mul_f32 v[72:73], v[72:73], v[104:105] op_sel_hi:[1,0]
    v_pk_mul_f32 v[74:75], v[74:75], v[104:105] op_sel_hi:[1,0]
    v_pk_mul_f32 v[76:77], v[76:77], v[104:105] op_sel_hi:[1,0]
    v_pk_mul_f32 v[78:79], v[78:79], v[104:105] op_sel_hi:[1,0]
    v_cvt_pk_bf16_f32 v40, v64, v65
    v_cvt_pk_bf16_f32 v41, v66, v67
    v_cvt_pk_bf16_f32 v42, v68, v69
    v_cvt_pk_bf16_f32 v43, v70, v71
    v_cvt_pk_bf16_f32 v44, v72, v73
    v_cvt_pk_bf16_f32 v45, v74, v75
    v_cvt_pk_bf16_f32 v46, v76, v77
    v_cvt_pk_bf16_f32 v47, v78, v79
    s_branch L_qepiE_16
L_qepiB_15:
    v_pk_mul_f32 v[96:97], v[64:65], s[62:63] op_sel_hi:[1,0]
    v_pk_mul_f32 v[98:99], v[66:67], s[62:63] op_sel_hi:[1,0]
    v_pk_mul_f32 v[100:101], v[68:69], s[62:63] op_sel_hi:[1,0]
    v_pk_mul_f32 v[102:103], v[70:71], s[62:63] op_sel_hi:[1,0]
    v_pk_mul_f32 v[104:105], v[72:73], s[62:63] op_sel_hi:[1,0]
    v_pk_mul_f32 v[106:107], v[74:75], s[62:63] op_sel_hi:[1,0]
    v_pk_mul_f32 v[108:109], v[76:77], s[62:63] op_sel_hi:[1,0]
    v_pk_mul_f32 v[110:111], v[78:79], s[62:63] op_sel_hi:[1,0]
    v_exp_f32 v96, v96
    v_exp_f32 v97, v97
    v_exp_f32 v98, v98
    v_exp_f32 v99, v99
    ds_read_b64_tr_b16 v[128:129], v7 offset:0
    v_exp_f32 v100, v100
    v_exp_f32 v101, v101
    ds_read_b64_tr_b16 v[130:131], v7 offset:512
    v_exp_f32 v102, v102
    v_exp_f32 v103, v103
    ds_read_b64_tr_b16 v[132:133], v7 offset:8192
    v_exp_f32 v104, v104
    v_exp_f32 v105, v105
    ds_read_b64_tr_b16 v[134:135], v7 offset:8704
    v_exp_f32 v106, v106
    v_exp_f32 v107, v107
    ds_read_b64_tr_b16 v[136:137], v7 offset:16384
    v_exp_f32 v108, v108
    v_exp_f32 v109, v109
    ds_read_b64_tr_b16 v[138:139], v7 offset:16896
    v_exp_f32 v110, v110
    v_exp_f32 v111, v111
    ds_read_b64_tr_b16 v[140:141], v7 offset:24576
    buffer_load_dwordx4 v[88:91], v29, s[36:39], s81 offen sc1
    v_pk_add_f32 v[64:65], v[64:65], 1.0 op_sel_hi:[1,0]
    v_pk_add_f32 v[66:67], v[66:67], 1.0 op_sel_hi:[1,0]
    ds_read_b64_tr_b16 v[142:143], v7 offset:25088
    s_waitcnt lgkmcnt(4)
    v_pk_add_f32 v[68:69], v[68:69], 1.0 op_sel_hi:[1,0]
    v_pk_add_f32 v[70:71], v[70:71], 1.0 op_sel_hi:[1,0]
    ds_read_b64_tr_b16 v[144:145], v7 offset:1024
    v_pk_add_f32 v[72:73], v[72:73], 1.0 op_sel_hi:[1,0]
    v_pk_add_f32 v[74:75], v[74:75], 1.0 op_sel_hi:[1,0]
    ds_read_b64_tr_b16 v[146:147], v7 offset:1536
    v_pk_add_f32 v[76:77], v[76:77], 1.0 op_sel_hi:[1,0]
    v_pk_add_f32 v[78:79], v[78:79], 1.0 op_sel_hi:[1,0]
    ds_read_b64_tr_b16 v[148:149], v7 offset:9216
    v_med3_f32 v64, v96, 1.0, v64
    v_med3_f32 v65, v97, 1.0, v65
    ds_read_b64_tr_b16 v[150:151], v7 offset:9728
    v_med3_f32 v66, v98, 1.0, v66
    v_med3_f32 v67, v99, 1.0, v67
    ds_read_b64_tr_b16 v[152:153], v7 offset:17408
    v_med3_f32 v68, v100, 1.0, v68
    v_med3_f32 v69, v101, 1.0, v69
    ds_read_b64_tr_b16 v[154:155], v7 offset:17920
    v_med3_f32 v70, v102, 1.0, v70
    v_med3_f32 v71, v103, 1.0, v71
    ds_read_b64_tr_b16 v[156:157], v7 offset:25600
    v_med3_f32 v72, v104, 1.0, v72
    v_med3_f32 v73, v105, 1.0, v73
    ds_read_b64_tr_b16 v[158:159], v7 offset:26112
    s_waitcnt lgkmcnt(4)
    v_med3_f32 v74, v106, 1.0, v74
    v_med3_f32 v75, v107, 1.0, v75
    ds_read_b64_tr_b16 v[160:161], v7 offset:2048
    v_med3_f32 v76, v108, 1.0, v76
    v_med3_f32 v77, v109, 1.0, v77
    ds_read_b64_tr_b16 v[162:163], v7 offset:2560
    v_med3_f32 v78, v110, 1.0, v78
    v_med3_f32 v79, v111, 1.0, v79
    ds_read_b64_tr_b16 v[164:165], v7 offset:10240
    v_pk_add_f32 v[64:65], v[64:65], s[98:99] op_sel_hi:[1,0]
    v_pk_add_f32 v[66:67], v[66:67], s[98:99] op_sel_hi:[1,0]
    ds_read_b64_tr_b16 v[166:167], v7 offset:10752
    v_pk_add_f32 v[68:69], v[68:69], s[98:99] op_sel_hi:[1,0]
    v_pk_add_f32 v[70:71], v[70:71], s[98:99] op_sel_hi:[1,0]
    ds_read_b64_tr_b16 v[168:169], v7 offset:18432
    v_pk_add_f32 v[72:73], v[72:73], s[98:99] op_sel_hi:[1,0]
    v_pk_add_f32 v[74:75], v[74:75], s[98:99] op_sel_hi:[1,0]
    ds_read_b64_tr_b16 v[170:171], v7 offset:18944
    v_pk_add_f32 v[76:77], v[76:77], s[98:99] op_sel_hi:[1,0]
    v_pk_add_f32 v[78:79], v[78:79], s[98:99] op_sel_hi:[1,0]
    ds_read_b64_tr_b16 v[172:173], v7 offset:26624
    v_cvt_pk_bf16_f32 v32, v64, v65
    v_cvt_pk_bf16_f32 v33, v66, v67
    ds_read_b64_tr_b16 v[174:175], v7 offset:27136
    s_waitcnt lgkmcnt(4)
    v_cvt_pk_bf16_f32 v34, v68, v69
    v_cvt_pk_bf16_f32 v35, v70, v71
    ds_read_b64_tr_b16 v[176:177], v7 offset:3072
    v_cvt_pk_bf16_f32 v36, v72, v73
    v_cvt_pk_bf16_f32 v37, v74, v75
    ds_read_b64_tr_b16 v[178:179], v7 offset:3584
    v_cvt_pk_bf16_f32 v38, v76, v77
    v_cvt_pk_bf16_f32 v39, v78, v79
    ds_read_b64_tr_b16 v[180:181], v7 offset:11264
    ds_read_b64_tr_b16 v[182:183], v7 offset:11776
    ds_read_b64_tr_b16 v[184:185], v7 offset:19456
    ds_read_b64_tr_b16 v[186:187], v7 offset:19968
    ds_read_b64_tr_b16 v[188:189], v7 offset:27648
    ds_read_b64_tr_b16 v[190:191], v7 offset:28160
L_qepiE_16:
    s_mov_b32 s84, 0
L_h1b_poll_17:
    s_waitcnt vmcnt(0)
    v_cmp_ne_u32 vcc, s59, v90
    s_cbranch_vccz L_h1b_done_18
    s_add_u32 s84, s84, 1
    s_cmp_lt_u32 s84, 100000
    s_cbranch_scc0 L_h1b_done_18
    s_sleep 4
    buffer_load_dwordx4 v[88:91], v29, s[36:39], s81 offen sc1
    s_branch L_h1b_poll_17
L_h1b_done_18:
    v_cmp_ne_u32 vcc, s23, v93
    s_nop 1
    s_cmp_eq_u64 vcc, 0
    s_cselect_b32 s23, 1, 0
    v_and_b32 v30, 15, v1
    s_cmp_lg_u32 s52, 0
    s_cbranch_scc1 L_h1bB_19
    ds_write_b64 v21, v[88:89]
    v_cmp_gt_u32 vcc, 2, v30
    s_branch L_h1bE_20
L_h1bB_19:
    ds_write_b32 v21, v88
    v_cmp_eq_u32 vcc, 0, v30
L_h1bE_20:
    s_nop 1
    s_and_saveexec_b64 s[66:67], vcc
    ds_write_b32 v22, v91
    s_mov_b64 exec, s[66:67]
    s_waitcnt lgkmcnt(0)
    s_barrier
    s_cmp_lg_u32 s52, 0
    s_cbranch_scc1 L_oB_21
    ds_read_b128 v[80:83], v23
    ds_read_b128 v[84:87], v23 offset:1024
    ds_read_b128 v[88:91], v23 offset:2048
    ds_read_b128 v[92:95], v23 offset:3072
    s_waitcnt lgkmcnt(2)
    v_mfma_f32_32x32x16_bf16 v[48:63], v[80:83], v[32:35], 0
    v_mfma_f32_32x32x16_bf16 v[48:63], v[84:87], v[36:39], v[48:63]
    s_waitcnt lgkmcnt(0)
    v_mfma_f32_32x32x16_bf16 v[64:79], v[88:91], v[40:43], 0
    v_mfma_f32_32x32x16_bf16 v[64:79], v[92:95], v[44:47], v[64:79]
    s_branch L_oE_22
L_oB_21:
    ds_read_b128 v[80:83], v23
    ds_read_b128 v[88:91], v23 offset:1024
    s_waitcnt lgkmcnt(1)
    s_nop 2
    v_mfma_f32_32x32x16_bf16 v[48:63], v[80:83], v[32:35], 0
    s_waitcnt lgkmcnt(0)
    s_nop 0
    v_mfma_f32_32x32x16_bf16 v[64:79], v[88:91], v[36:39], 0
L_oE_22:
    s_lshl_b32 s95, s53, 18
    s_lshl_b32 s66, s52, 10
    s_add_u32 s95, s95, s66
    s_lshl_b32 s65, s54, 15
    s_add_u32 s65, s65, s95
    s_lshl_b32 s66, s56, 12
    s_add_u32 s65, s65, s66
    s_nop 6
    v_add_f32 v96, s98, v56
    v_rcp_f32 v96, v96
    s_nop 0
    v_pk_mul_f32 v[48:49], v[48:49], v[96:97] op_sel_hi:[1,0]
    v_pk_mul_f32 v[50:51], v[50:51], v[96:97] op_sel_hi:[1,0]
    v_pk_mul_f32 v[52:53], v[52:53], v[96:97] op_sel_hi:[1,0]
    v_pk_mul_f32 v[54:55], v[54:55], v[96:97] op_sel_hi:[1,0]
    v_cvt_pk_bf16_f32 v80, v48, v49
    v_cvt_pk_bf16_f32 v81, v50, v51
    v_cvt_pk_bf16_f32 v82, v52, v53
    v_cvt_pk_bf16_f32 v83, v54, v55
    v_add_f32 v98, s98, v72
    v_rcp_f32 v98, v98
    s_nop 0
    v_pk_mul_f32 v[64:65], v[64:65], v[98:99] op_sel_hi:[1,0]
    v_pk_mul_f32 v[66:67], v[66:67], v[98:99] op_sel_hi:[1,0]
    v_pk_mul_f32 v[68:69], v[68:69], v[98:99] op_sel_hi:[1,0]
    v_pk_mul_f32 v[70:71], v[70:71], v[98:99] op_sel_hi:[1,0]
    v_cvt_pk_bf16_f32 v84, v64, v65
    v_cvt_pk_bf16_f32 v85, v66, v67
    v_cvt_pk_bf16_f32 v86, v68, v69
    v_cvt_pk_bf16_f32 v87, v70, v71
    s_cmp_eq_u32 s23, 0
    s_cbranch_scc1 L_oslow_23
    buffer_store_dwordx4 v[80:83], v26, s[40:43], s65 offen
    buffer_store_dwordx4 v[84:87], v26, s[40:43], s65 offen offset:2048
    s_branch L_odone_24
L_oslow_23:
    buffer_store_dwordx4 v[80:83], v26, s[40:43], s65 offen sc1
    buffer_store_dwordx4 v[84:87], v26, s[40:43], s65 offen offset:2048 sc1
L_odone_24:
    ds_write_b128 v24, v[80:83]
    ds_write_b128 v24, v[84:87] offset:4096
    ds_read_b64_tr_b16 v[192:193], v7 offset:32768
    ds_read_b64_tr_b16 v[194:195], v7 offset:33280
    ds_read_b64_tr_b16 v[196:197], v7 offset:40960
    ds_read_b64_tr_b16 v[198:199], v7 offset:41472
    ds_read_b64_tr_b16 v[200:201], v7 offset:49152
    ds_read_b64_tr_b16 v[202:203], v7 offset:49664
    ds_read_b64_tr_b16 v[204:205], v7 offset:57344
    ds_read_b64_tr_b16 v[206:207], v7 offset:57856
    s_waitcnt lgkmcnt(7)
    ds_read_b64_tr_b16 v[208:209], v7 offset:33792
    ds_read_b64_tr_b16 v[210:211], v7 offset:34304
    ds_read_b64_tr_b16 v[212:213], v7 offset:41984
    ds_read_b64_tr_b16 v[214:215], v7 offset:42496
    ds_read_b64_tr_b16 v[216:217], v7 offset:50176
    ds_read_b64_tr_b16 v[218:219], v7 offset:50688
    ds_read_b64_tr_b16 v[220:221], v7 offset:58368
    ds_read_b64_tr_b16 v[222:223], v7 offset:58880
    s_waitcnt lgkmcnt(7)
    ds_read_b64_tr_b16 v[224:225], v7 offset:34816
    ds_read_b64_tr_b16 v[226:227], v7 offset:35328
    ds_read_b64_tr_b16 v[228:229], v7 offset:43008
    ds_read_b64_tr_b16 v[230:231], v7 offset:43520
    ds_read_b64_tr_b16 v[232:233], v7 offset:51200
    ds_read_b64_tr_b16 v[234:235], v7 offset:51712
    ds_read_b64_tr_b16 v[236:237], v7 offset:59392
    ds_read_b64_tr_b16 v[238:239], v7 offset:59904
    s_waitcnt lgkmcnt(7)
    ds_read_b64_tr_b16 v[240:241], v7 offset:35840
    ds_read_b64_tr_b16 v[242:243], v7 offset:36352
    ds_read_b64_tr_b16 v[244:245], v7 offset:44032
    ds_read_b64_tr_b16 v[246:247], v7 offset:44544
    ds_read_b64_tr_b16 v[248:249], v7 offset:52224
    ds_read_b64_tr_b16 v[250:251], v7 offset:52736
    ds_read_b64_tr_b16 v[252:253], v7 offset:60416
    ds_read_b64_tr_b16 v[254:255], v7 offset:60928
    s_lshl_b32 s64, s58, 13
    v_subrev_u32 v8, s64, v24
    s_waitcnt vmcnt(0) lgkmcnt(0)
    s_barrier
    s_lshl_b32 s64, s52, 4
    s_add_u32 s64, s64, s53
    s_lshl_b32 s64, s64, 10
    s_add_u32 s64, s64, 4096
    s_cmp_lg_u32 s56, 0
    s_cbranch_scc1 L_nofl_25
    s_lshl_b32 s65, s54, 7
    s_add_u32 s65, s65, s64
    v_mov_b32 v96, 0
    v_mov_b32 v97, s59
    s_mov_b64 exec, 1
    s_cmp_eq_u32 s23, 0
    s_cbranch_scc1 L_flslow_26
    buffer_store_dword v97, v96, s[36:39], s65 offen
    s_branch L_fldone_27
L_flslow_26:
    buffer_store_dword v97, v96, s[36:39], s65 offen sc1
L_fldone_27:
    s_mov_b64 exec, -1
L_nofl_25:
    v_and_b32 v104, 31, v1
    s_lshl_b32 s65, s57, 5
    v_add_u32 v104, s65, v104
    v_lshrrev_b32 v105, 5, v1
    s_lshl_b32 s65, s58, 2
    v_add_u32 v105, s65, v105
    v_and_b32 v106, 7, v104
    v_xor_b32 v105, v105, v106
    v_lshlrev_b32 v105, 4, v105
    v_lshl_add_u32 v105, v104, 7, v105
    v_add_u32 v100, 139264, v105
    v_xor_b32 v101, 32, v100
    s_lshl_b32 s65, s56, 11
    s_add_u32 s65, s65, 139264
    v_add_u32 v102, s65, v26
    v_lshrrev_b32 v104, 3, v1
    v_and_b32 v105, 7, v1
    v_xor_b32 v105, v105, v104
    s_lshl_b32 s65, s53, 7
    s_lshl_b32 s67, s56, 4
    s_add_u32 s65, s65, s67
    v_add_u32 v104, s65, v104
    v_lshlrev_b32 v104, 11, v104
    v_lshl_add_u32 v103, v105, 4, v104
    s_lshl_b32 s82, s52, 10
    s_lshl_b32 s65, s54, 7
    s_add_u32 s82, s82, s65
    s_add_u32 s83, s82, 16384
    ds_read_b128 v[32:35], v8 offset:0
    ds_read_b128 v[36:39], v8 offset:4096
    ds_read_b128 v[40:43], v8 offset:8192
    ds_read_b128 v[44:47], v8 offset:12288
    s_waitcnt lgkmcnt(3)
    v_mfma_f32_32x32x16_bf16 v[64:79], v[128:131], v[32:35], 0
    s_waitcnt lgkmcnt(2)
    v_mfma_f32_32x32x16_bf16 v[64:79], v[132:135], v[36:39], v[64:79]
    s_waitcnt lgkmcnt(1)
    v_mfma_f32_32x32x16_bf16 v[64:79], v[136:139], v[40:43], v[64:79]
    s_waitcnt lgkmcnt(0)
    v_mfma_f32_32x32x16_bf16 v[64:79], v[140:143], v[44:47], v[64:79]
    s_cmp_lg_u32 s56, 0
    s_cbranch_scc1 L_nopoll_28
    v_and_b32 v96, 7, v1
    v_lshlrev_b32 v96, 7, v96
    s_mov_b32 s84, 0
    buffer_load_dword v97, v96, s[36:39], s64 offen sc1
L_h2_poll_29:
    s_waitcnt vmcnt(0)
    v_cmp_ne_u32 vcc, s59, v97
    s_cbranch_vccz L_h2_done_30
    s_add_u32 s84, s84, 1
    s_cmp_lt_u32 s84, 100000
    s_cbranch_scc0 L_h2_done_30
    s_sleep 4
    buffer_load_dword v97, v96, s[36:39], s64 offen sc1
    s_branch L_h2_poll_29
L_h2_done_30:
L_nopoll_28:
    s_barrier
    s_lshl_b32 s66, s56, 11
    s_add_u32 s76, s54, 1
    s_and_b32 s76, s76, 7
    s_lshl_b32 s76, s76, 15
    s_add_u32 s76, s76, s95
    s_add_u32 m0, s66, 16384
    s_nop 0
    buffer_load_dwordx4 v27, s[40:43], s76 offen sc1 lds
    s_add_u32 m0, s66, 17408
    s_nop 0
    buffer_load_dwordx4 v28, s[40:43], s76 offen sc1 lds
    s_add_u32 s76, s54, 2
    s_and_b32 s76, s76, 7
    s_lshl_b32 s76, s76, 15
    s_add_u32 s76, s76, s95
    s_add_u32 m0, s66, 32768
    s_nop 0
    buffer_load_dwordx4 v27, s[40:43], s76 offen sc1 lds
    s_add_u32 m0, s66, 33792
    s_nop 0
    buffer_load_dwordx4 v28, s[40:43], s76 offen sc1 lds
    s_add_u32 s76, s54, 3
    s_and_b32 s76, s76, 7
    s_lshl_b32 s76, s76, 15
    s_add_u32 s76, s76, s95
    s_add_u32 m0, s66, 49152
    s_nop 0
    buffer_load_dwordx4 v27, s[40:43], s76 offen sc1 lds
    s_add_u32 m0, s66, 50176
    s_nop 0
    buffer_load_dwordx4 v28, s[40:43], s76 offen sc1 lds
    v_xor_b32 v9, 0x10000, v8
    s_waitcnt vmcnt(4)
    s_barrier
    ds_read_b128 v[48:51], v8 offset:16384
    ds_read_b128 v[52:55], v8 offset:20480
    ds_read_b128 v[56:59], v8 offset:24576
    ds_read_b128 v[60:63], v8 offset:28672
    s_waitcnt vmcnt(2)
    s_barrier
    s_waitcnt lgkmcnt(3)
    v_mfma_f32_32x32x16_bf16 v[64:79], v[144:147], v[48:51], v[64:79]
    ds_read_b128 v[32:35], v8 offset:32768
    s_add_u32 s76, s54, 4
    s_and_b32 s76, s76, 7
    s_lshl_b32 s76, s76, 15
    s_add_u32 s76, s76, s95
    s_add_u32 m0, s66, 65536
    s_nop 0
    buffer_load_dwordx4 v27, s[40:43], s76 offen sc1 lds
    s_waitcnt lgkmcnt(3)
    v_mfma_f32_32x32x16_bf16 v[64:79], v[148:151], v[52:55], v[64:79]
    ds_read_b128 v[36:39], v8 offset:36864
    s_waitcnt lgkmcnt(3)
    v_mfma_f32_32x32x16_bf16 v[64:79], v[152:155], v[56:59], v[64:79]
    ds_read_b128 v[40:43], v8 offset:40960
    s_add_u32 m0, s66, 66560
    s_nop 0
    buffer_load_dwordx4 v28, s[40:43], s76 offen sc1 lds
    s_waitcnt lgkmcnt(3)
    v_mfma_f32_32x32x16_bf16 v[64:79], v[156:159], v[60:63], v[64:79]
    ds_read_b128 v[44:47], v8 offset:45056
    s_waitcnt vmcnt(2)
    s_barrier
    s_waitcnt lgkmcnt(3)
    v_mfma_f32_32x32x16_bf16 v[64:79], v[160:163], v[32:35], v[64:79]
    ds_read_b128 v[48:51], v8 offset:49152
    s_add_u32 s76, s54, 5
    s_and_b32 s76, s76, 7
    s_lshl_b32 s76, s76, 15
    s_add_u32 s76, s76, s95
    s_add_u32 m0, s66, 81920
    s_nop 0
    buffer_load_dwordx4 v27, s[40:43], s76 offen sc1 lds
    s_waitcnt lgkmcnt(3)
    v_mfma_f32_32x32x16_bf16 v[64:79], v[164:167], v[36:39], v[64:79]
    ds_read_b128 v[52:55], v8 offset:53248
    s_waitcnt lgkmcnt(3)
    v_mfma_f32_32x32x16_bf16 v[64:79], v[168:171], v[40:43], v[64:79]
    ds_read_b128 v[56:59], v8 offset:57344
    s_add_u32 m0, s66, 82944
    s_nop 0
    buffer_load_dwordx4 v28, s[40:43], s76 offen sc1 lds
    s_waitcnt lgkmcnt(3)
    v_mfma_f32_32x32x16_bf16 v[64:79], v[172:175], v[44:47], v[64:79]
    ds_read_b128 v[60:63], v8 offset:61440
    s_waitcnt vmcnt(2)
    s_barrier
    s_waitcnt lgkmcnt(3)
    v_mfma_f32_32x32x16_bf16 v[64:79], v[176:179], v[48:51], v[64:79]
    ds_read_b128 v[32:35], v9 offset:0
    s_add_u32 s76, s54, 6
    s_and_b32 s76, s76, 7
    s_lshl_b32 s76, s76, 15
    s_add_u32 s76, s76, s95
    s_add_u32 m0, s66, 98304
    s_nop 0
    buffer_load_dwordx4 v27, s[40:43], s76 offen sc1 lds
    s_waitcnt lgkmcnt(3)
    v_mfma_f32_32x32x16_bf16 v[64:79], v[180:183], v[52:55], v[64:79]
    ds_read_b128 v[36:39], v9 offset:4096
    s_waitcnt lgkmcnt(3)
    v_mfma_f32_32x32x16_bf16 v[64:79], v[184:187], v[56:59], v[64:79]
    ds_read_b128 v[40:43], v9 offset:8192
    s_add_u32 m0, s66, 99328
    s_nop 0
    buffer_load_dwordx4 v28, s[40:43], s76 offen sc1 lds
    s_waitcnt lgkmcnt(3)
    v_mfma_f32_32x32x16_bf16 v[64:79], v[188:191], v[60:63], v[64:79]
    ds_read_b128 v[44:47], v9 offset:12288
    s_waitcnt vmcnt(2)
    s_barrier
    s_waitcnt lgkmcnt(3)
    v_mfma_f32_32x32x16_bf16 v[64:79], v[192:195], v[32:35], v[64:79]
    ds_read_b128 v[48:51], v9 offset:16384
    s_add_u32 s76, s54, 7
    s_and_b32 s76, s76, 7
    s_lshl_b32 s76, s76, 15
    s_add_u32 s76, s76, s95
    s_add_u32 m0, s66, 114688
    s_nop 0
    buffer_load_dwordx4 v27, s[40:43], s76 offen sc1 lds
    s_waitcnt lgkmcnt(3)
    v_mfma_f32_32x32x16_bf16 v[64:79], v[196:199], v[36:39], v[64:79]
    ds_read_b128 v[52:55], v9 offset:20480
    s_waitcnt lgkmcnt(3)
    v_mfma_f32_32x32x16_bf16 v[64:79], v[200:203], v[40:43], v[64:79]
    ds_read_b128 v[56:59], v9 offset:24576
    s_add_u32 m0, s66, 115712
    s_nop 0
    buffer_load_dwordx4 v28, s[40:43], s76 offen sc1 lds
    s_waitcnt lgkmcnt(3)
    v_mfma_f32_32x32x16_bf16 v[64:79], v[204:207], v[44:47], v[64:79]
    ds_read_b128 v[60:63], v9 offset:28672
    s_waitcnt vmcnt(2)
    s_barrier
    s_waitcnt lgkmcnt(3)
    v_mfma_f32_32x32x16_bf16 v[64:79], v[208:211], v[48:51], v[64:79]
    ds_read_b128 v[32:35], v9 offset:32768
    s_waitcnt lgkmcnt(3)
    v_mfma_f32_32x32x16_bf16 v[64:79], v[212:215], v[52:55], v[64:79]
    ds_read_b128 v[36:39], v9 offset:36864
    s_waitcnt lgkmcnt(3)
    v_mfma_f32_32x32x16_bf16 v[64:79], v[216:219], v[56:59], v[64:79]
    ds_read_b128 v[40:43], v9 offset:40960
    s_waitcnt lgkmcnt(3)
    v_mfma_f32_32x32x16_bf16 v[64:79], v[220:223], v[60:63], v[64:79]
    ds_read_b128 v[44:47], v9 offset:45056
    s_waitcnt vmcnt(0)
    s_barrier
    s_cmp_lg_u32 s56, 0
    s_cbranch_scc1 L_nog2_31
    s_lshl_b32 s65, s54, 7
    s_add_u32 s65, s65, s64
    v_mov_b32 v97, s59
    s_mov_b64 exec, 1
    s_cmp_eq_u32 s23, 0
    s_cbranch_scc1 L_g2slow_32
    buffer_store_dword v97, v26, s[36:39], s65 offen offset:64
    s_branch L_g2done_33
L_g2slow_32:
    buffer_store_dword v97, v26, s[36:39], s65 offen offset:64 sc1
L_g2done_33:
    s_mov_b64 exec, -1
L_nog2_31:
    s_waitcnt lgkmcnt(3)
    v_mfma_f32_32x32x16_bf16 v[64:79], v[224:227], v[32:35], v[64:79]
    ds_read_b128 v[48:51], v9 offset:49152
    s_waitcnt lgkmcnt(3)
    v_mfma_f32_32x32x16_bf16 v[64:79], v[228:231], v[36:39], v[64:79]
    ds_read_b128 v[52:55], v9 offset:53248
    s_waitcnt lgkmcnt(3)
    v_mfma_f32_32x32x16_bf16 v[64:79], v[232:235], v[40:43], v[64:79]
    ds_read_b128 v[56:59], v9 offset:57344
    s_waitcnt lgkmcnt(3)
    v_mfma_f32_32x32x16_bf16 v[64:79], v[236:239], v[44:47], v[64:79]
    ds_read_b128 v[60:63], v9 offset:61440
    s_waitcnt lgkmcnt(3)
    v_mfma_f32_32x32x16_bf16 v[64:79], v[240:243], v[48:51], v[64:79]
    s_waitcnt lgkmcnt(2)
    v_mfma_f32_32x32x16_bf16 v[64:79], v[244:247], v[52:55], v[64:79]
    s_waitcnt lgkmcnt(1)
    v_mfma_f32_32x32x16_bf16 v[64:79], v[248:251], v[56:59], v[64:79]
    s_waitcnt lgkmcnt(0)
    v_mfma_f32_32x32x16_bf16 v[64:79], v[252:255], v[60:63], v[64:79]
    s_cmp_lg_u32 s56, 0
    s_cbranch_scc1 L_nopoll2_34
    v_and_b32 v96, 7, v1
    v_lshlrev_b32 v96, 7, v96
    s_mov_b32 s84, 0
    buffer_load_dword v97, v96, s[36:39], s64 offen offset:64 sc1
L_g2_poll_35:
    s_waitcnt vmcnt(0)
    v_cmp_ne_u32 vcc, s59, v97
    s_cbranch_vccz L_g2_done_36
    s_add_u32 s84, s84, 1
    s_cmp_lt_u32 s84, 100000
    s_cbranch_scc0 L_g2_done_36
    s_sleep 4
    buffer_load_dword v97, v96, s[36:39], s64 offen offset:64 sc1
    s_branch L_g2_poll_35
L_g2_done_36:
L_nopoll2_34:
    v_cvt_pk_bf16_f32 v32, v64, v65
    v_cvt_pk_bf16_f32 v33, v66, v67
    v_cvt_pk_bf16_f32 v34, v68, v69
    v_cvt_pk_bf16_f32 v35, v70, v71
    v_cvt_pk_bf16_f32 v36, v72, v73
    v_cvt_pk_bf16_f32 v37, v74, v75
    v_cvt_pk_bf16_f32 v38, v76, v77
    v_cvt_pk_bf16_f32 v39, v78, v79
    v_permlane32_swap_b32 v32, v34
    v_permlane32_swap_b32 v33, v35
    v_permlane32_swap_b32 v36, v38
    v_permlane32_swap_b32 v37, v39
    s_lshl_b32 s64, s52, 10
    s_lshl_b32 s65, s54, 7
    s_add_u32 s64, s64, s65
    s_lshl_b32 s65, s58, 6
    s_add_u32 s64, s64, s65
    ds_write_b128 v100, v[32:35]
    ds_write_b128 v101, v[36:39]
    s_waitcnt lgkmcnt(0)
    s_barrier
    ds_read_b128 v[32:35], v102
    ds_read_b128 v[36:39], v102 offset:1024
    s_waitcnt lgkmcnt(1)
    buffer_store_dwordx4 v[32:35], v103, s[40:43], s82 offen
    s_waitcnt lgkmcnt(0)
    buffer_store_dwordx4 v[36:39], v103, s[40:43], s83 offen
    s_or_b32 s64, s53, s54
    s_or_b32 s64, s64, s56
    s_cmp_lg_u32 s64, 0
    s_cbranch_scc1 L_nog_37
    s_add_u32 s65, s60, 1
    s_lshl_b32 s66, s52, 8
    v_mov_b32 v96, 0
    v_mov_b32 v97, s65
    s_mov_b64 exec, 1
    buffer_store_dword v97, v96, s[36:39], s66 offen
    s_mov_b64 exec, -1
L_nog_37:
L_END:
    s_endpgm
.section .rodata,"a"
.p2align 6
.amdhsa_kernel concat_heads__linear_kernel_hedgehog__linear_attn_block__prompt_kernel
  .amdhsa_next_free_vgpr 256
  .amdhsa_next_free_sgpr 102
  .amdhsa_accum_offset 256
  .amdhsa_group_segment_fixed_size 0
  .amdhsa_kernarg_size 80
  .amdhsa_user_sgpr_count 2
  .amdhsa_user_sgpr_kernarg_segment_ptr 1
  .amdhsa_system_sgpr_workgroup_id_x 1
.end_amdhsa_kernel
```
